```python
import torch

def _softmax(x, axis=-1):
    return torch.softmax(x, dim=axis)
def _gelu(x):
    return torch.nn.functional.gelu(x, approximate="tanh")
def _silu(x):
    return torch.nn.functional.silu(x)
def _sigmoid(x):
    return torch.sigmoid(x)
def _layernorm(x, axis=-1, eps=1e-5):
    m = x.mean(dim=axis, keepdim=True)
    v = x.var(dim=axis, keepdim=True, unbiased=False)
    return (x - m) / torch.sqrt(v + eps)
def _scatter_add(tgt, idx, src, axis=0):
    return tgt.clone().index_add_(axis, idx, src)
def _segment_sum(src, seg, n):
    out = torch.zeros((n,) + src.shape[1:], dtype=src.dtype)
    return out.index_add_(0, seg, src)
def _pad(x, pw):
    flat = tuple(v for pair in reversed(pw) for v in pair)
    return torch.nn.functional.pad(x, flat)

kernel_name = 'parallel_sum__gqa_block_cached__dense_activation_squared_relu__decode'

def setup_inputs():

    _w = (lambda a: (lambda t: t.to(torch.bfloat16) if t.is_floating_point() else t)(torch.as_tensor(a)))
    def _A_setup():
        B, Sq, D = 4, 1, 640
        Hq, Hkv, Sk, Dh = 32, 32, 8192, 128
        assert Hq % Hkv == 0, (Hq, Hkv)
        return {
            "x": _w((lambda *s: torch.randn(*s, dtype=torch.bfloat16) * 0.05)(B, Sq, D)),
            "k_cache": _w((lambda *s: torch.randn(*s, dtype=torch.bfloat16) * 1.6)(B, Hkv, Sk, Dh)),
            "v_cache": _w((lambda *s: torch.randn(*s, dtype=torch.bfloat16) * 3.2)(B, Hkv, Sk, Dh)),
            "wq": _w((lambda *s: torch.randn(*s, dtype=torch.bfloat16) * 1.6)(D, Hq * Dh) * (D ** -0.5)),
            "wo": _w((lambda *s: torch.randn(*s, dtype=torch.bfloat16) * 3.2)(Hq * Dh, D) * ((Hq * Dh) ** -0.5)),
        }
    _A_in = _A_setup()

    def _B_setup():
        B, S, D, F = 4, 1, 640, 1728
        return {
            "x": _w((lambda *s: torch.randn(*s, dtype=torch.bfloat16) * 0.05)(B, S, D)),
            "w1": _w((lambda *s: torch.randn(*s, dtype=torch.bfloat16) * 0.05)(D, F)),
            "b1": _w((lambda *s: torch.randn(*s, dtype=torch.bfloat16) * 0.4)(F)),
            "w2": _w((lambda *s: torch.randn(*s, dtype=torch.bfloat16) * 0.05)(F, D)),
            "b2": _w((lambda *s: torch.randn(*s, dtype=torch.bfloat16) * 1.6)(D)),
        }
    _B_in = _B_setup()

    return {
        "A_x": _A_in["x"],
        "A_k_cache": _A_in["k_cache"],
        "A_v_cache": _A_in["v_cache"],
        "A_wq": _A_in["wq"],
        "A_wo": _A_in["wo"],
        "B_x": _B_in["x"],
        "B_w1": _B_in["w1"],
        "B_b1": _B_in["b1"],
        "B_w2": _B_in["w2"],
        "B_b2": _B_in["b2"],
    }

def reference(A_x, A_k_cache, A_v_cache, A_wq, A_wo, B_x, B_w1, B_b1, B_w2, B_b2):
    def _A_ref(x, k_cache, v_cache, wq, wo):
        B, Sq, D = x.shape
        Hq, Dh = 32, 128
        Hkv = k_cache.shape[1]
        rep = Hq // Hkv
        q = (lambda x, *d: x.permute(*d))((x @ wq).reshape(B, Sq, Hq, Dh), 0, 2, 1, 3)
        k = (lambda x, n, axis: torch.repeat_interleave(x, n, dim=axis))(k_cache, rep, axis=1)
        v = (lambda x, n, axis: torch.repeat_interleave(x, n, dim=axis))(v_cache, rep, axis=1)
        scores = torch.einsum("bhqd,bhkd->bhqk", q, k) * (Dh ** -0.5)
        p = _softmax(scores, axis=-1)
        o = torch.einsum("bhqk,bhkd->bhqd", p, v)
        return (lambda x, *d: x.permute(*d))(o, 0, 2, 1, 3).reshape(B, Sq, Hq * Dh) @ wo

    def _B_ref(x, w1, b1, w2, b2):
        h = torch.einsum("bsd,df->bsf", x, w1) + b1
        zero = torch.zeros_like(h)
        r = torch.where(h > zero, h, zero)
        h = r * r
        out = torch.einsum("bsf,fd->bsd", h, w2) + b2
        return out

    x = A_x
    xn = _layernorm(x, axis=-1)
    return x + _A_ref(xn, A_k_cache, A_v_cache, A_wq, A_wo) + _B_ref(xn, B_w1, B_b1, B_w2, B_b2)
```

```asm
; @launch grid=(256,1,1) block=(512,1,1) lds=63488
.amdgcn_target "amdgcn-amd-amdhsa--gfx950"
.text
.globl parallel_sum__gqa_block_cached__dense_activation_squared_relu__decode_kernel
.p2align 8
.type parallel_sum__gqa_block_cached__dense_activation_squared_relu__decode_kernel,@function
parallel_sum__gqa_block_cached__dense_activation_squared_relu__decode_kernel:
    s_cmp_ge_u32 s2, 256
    s_cbranch_scc1 L_end
    s_load_dwordx16 s[4:19], s[0:1], 0
    s_load_dwordx8 s[20:27], s[0:1], 64
    s_load_dwordx2 s[28:29], s[0:1], 96
    v_lshrrev_b32 v1, 6, v0
    s_lshr_b32 s30, s2, 3
    v_readfirstlane_b32 s3, v1
    s_and_b32 s31, s2, 7
    v_and_b32 v1, 63, v0
    s_lshr_b32 s32, s31, 1
    s_xor_b32 s32, s32, s31
    s_and_b32 s32, s32, 1
    s_lshr_b32 s33, s31, 1
    s_cmp_ge_u32 s3, 4
    s_cbranch_scc1 L_aux
    s_and_b32 s34, s3, 1
    s_lshl_b32 s35, s32, 1
    s_add_u32 s35, s35, s34
    s_lshl_b32 s52, s35, 5
    s_add_u32 s52, s52, s30
    s_lshr_b32 s53, s3, 1
    s_lshl_b32 s54, s33, 1
    s_add_u32 s53, s53, s54
    s_lshl_b32 s54, s52, 21
    v_and_b32 v2, 15, v1
    v_lshlrev_b32 v1, 4, v1
    s_lshl_b32 s47, s53, 14
    v_add_u32 v44, s47, v1
    v_add_u32 v45, 4096, v44
    v_add_u32 v46, 8192, v44
    v_add_u32 v47, 12288, v44
    v_add_u32 v241, 131072, v44
    v_add_u32 v242, 4096, v241
    v_add_u32 v243, 8192, v241
    v_add_u32 v244, 12288, v241
    s_mov_b32 s43, 0xffff0000
    s_mov_b32 s34, 0x200000
    s_mov_b32 s35, 0x20000
    s_mov_b32 s38, 0x200000
    s_mov_b32 s39, 0x20000
    s_lshl_b32 s55, s52, 8
    s_cmp_lg_u32 s3, 0
    s_cbranch_scc1 L_z_1
    v_mov_b32 v36, 19968
    v_mov_b32 v48, 0
    v_mov_b32 v49, 0
    v_mov_b32 v50, 0
    v_mov_b32 v51, 0
    ds_write_b128 v36, v[48:51]
    ds_write_b128 v36, v[48:51] offset:16
L_z_1:
    s_waitcnt lgkmcnt(0)
    s_add_u32 s32, s6, s54
    s_addc_u32 s33, s7, 0
    s_add_u32 s36, s8, s54
    s_addc_u32 s37, s9, 0
    s_add_u32 s44, s28, s55
    s_addc_u32 s45, s29, 0
    s_barrier
    buffer_load_dwordx4 v[48:51], v44, s[32:35], 0 offen offset:0 nt
    buffer_load_dwordx4 v[52:55], v44, s[32:35], 0 offen offset:1024 nt
    buffer_load_dwordx4 v[56:59], v44, s[32:35], 0 offen offset:2048 nt
    buffer_load_dwordx4 v[60:63], v44, s[32:35], 0 offen offset:3072 nt
    buffer_load_dwordx4 v[64:67], v45, s[32:35], 0 offen offset:0 nt
    buffer_load_dwordx4 v[68:71], v45, s[32:35], 0 offen offset:1024 nt
    s_waitcnt vmcnt(5)
    buffer_load_dwordx4 v[72:75], v45, s[32:35], 0 offen offset:2048 nt
    s_waitcnt vmcnt(5)
    buffer_load_dwordx4 v[76:79], v45, s[32:35], 0 offen offset:3072 nt
    s_waitcnt vmcnt(5)
    buffer_load_dwordx4 v[80:83], v46, s[32:35], 0 offen offset:0 nt
    s_waitcnt vmcnt(5)
    buffer_load_dwordx4 v[84:87], v46, s[32:35], 0 offen offset:1024 nt
    s_waitcnt vmcnt(5)
    buffer_load_dwordx4 v[88:91], v46, s[32:35], 0 offen offset:2048 nt
    s_waitcnt vmcnt(5)
    buffer_load_dwordx4 v[92:95], v46, s[32:35], 0 offen offset:3072 nt
    s_waitcnt vmcnt(5)
    buffer_load_dwordx4 v[96:99], v47, s[32:35], 0 offen offset:0 nt
    s_waitcnt vmcnt(5)
    buffer_load_dwordx4 v[100:103], v47, s[32:35], 0 offen offset:1024 nt
    s_waitcnt vmcnt(5)
    buffer_load_dwordx4 v[104:107], v47, s[32:35], 0 offen offset:2048 nt
    s_waitcnt vmcnt(5)
    buffer_load_dwordx4 v[108:111], v47, s[32:35], 0 offen offset:3072 nt
    s_waitcnt vmcnt(5)
    buffer_load_dwordx4 v[112:115], v44, s[36:39], 0 offen offset:0 nt
    s_waitcnt vmcnt(5)
    buffer_load_dwordx4 v[116:119], v44, s[36:39], 0 offen offset:1024 nt
    s_waitcnt vmcnt(5)
    buffer_load_dwordx4 v[120:123], v44, s[36:39], 0 offen offset:2048 nt
    s_waitcnt vmcnt(5)
    buffer_load_dwordx4 v[124:127], v44, s[36:39], 0 offen offset:3072 nt
    s_waitcnt vmcnt(5)
    buffer_load_dwordx4 v[128:131], v45, s[36:39], 0 offen offset:0 nt
    s_waitcnt vmcnt(5)
    buffer_load_dwordx4 v[132:135], v45, s[36:39], 0 offen offset:1024 nt
    s_waitcnt vmcnt(5)
    buffer_load_dwordx4 v[136:139], v45, s[36:39], 0 offen offset:2048 nt
    s_waitcnt vmcnt(5)
    buffer_load_dwordx4 v[140:143], v45, s[36:39], 0 offen offset:3072 nt
    s_waitcnt vmcnt(5)
    buffer_load_dwordx4 v[144:147], v46, s[36:39], 0 offen offset:0 nt
    s_waitcnt vmcnt(5)
    buffer_load_dwordx4 v[148:151], v46, s[36:39], 0 offen offset:1024 nt
    s_waitcnt vmcnt(5)
    buffer_load_dwordx4 v[152:155], v46, s[36:39], 0 offen offset:2048 nt
    s_waitcnt vmcnt(5)
    buffer_load_dwordx4 v[156:159], v46, s[36:39], 0 offen offset:3072 nt
    s_waitcnt vmcnt(5)
    buffer_load_dwordx4 v[160:163], v47, s[36:39], 0 offen offset:0 nt
    s_waitcnt vmcnt(5)
    buffer_load_dwordx4 v[164:167], v47, s[36:39], 0 offen offset:1024 nt
    s_waitcnt vmcnt(5)
    buffer_load_dwordx4 v[168:171], v47, s[36:39], 0 offen offset:2048 nt
    s_waitcnt vmcnt(5)
    buffer_load_dwordx4 v[172:175], v47, s[36:39], 0 offen offset:3072 nt
    s_waitcnt vmcnt(5)
    buffer_load_dwordx4 v[176:179], v241, s[32:35], 0 offen offset:0 nt
    s_waitcnt vmcnt(5)
    buffer_load_dwordx4 v[180:183], v241, s[32:35], 0 offen offset:1024 nt
    s_waitcnt vmcnt(5)
    buffer_load_dwordx4 v[184:187], v241, s[32:35], 0 offen offset:2048 nt
    s_waitcnt vmcnt(5)
    buffer_load_dwordx4 v[188:191], v241, s[32:35], 0 offen offset:3072 nt
    s_waitcnt vmcnt(5)
    buffer_load_dwordx4 v[192:195], v242, s[32:35], 0 offen offset:0 nt
    s_waitcnt vmcnt(5)
    buffer_load_dwordx4 v[196:199], v242, s[32:35], 0 offen offset:1024 nt
    s_waitcnt vmcnt(5)
    buffer_load_dwordx4 v[200:203], v242, s[32:35], 0 offen offset:2048 nt
    s_waitcnt vmcnt(5)
    buffer_load_dwordx4 v[204:207], v242, s[32:35], 0 offen offset:3072 nt
    s_waitcnt vmcnt(5)
    buffer_load_dwordx4 v[208:211], v243, s[32:35], 0 offen offset:0 nt
    s_waitcnt vmcnt(5)
    buffer_load_dwordx4 v[212:215], v243, s[32:35], 0 offen offset:1024 nt
    s_waitcnt vmcnt(5)
    buffer_load_dwordx4 v[216:219], v243, s[32:35], 0 offen offset:2048 nt
    s_waitcnt vmcnt(5)
    buffer_load_dwordx4 v[220:223], v243, s[32:35], 0 offen offset:3072 nt
    s_waitcnt vmcnt(5)
    buffer_load_dwordx4 v[224:227], v244, s[32:35], 0 offen offset:0 nt
    s_waitcnt vmcnt(5)
    buffer_load_dwordx4 v[228:231], v244, s[32:35], 0 offen offset:1024 nt
    s_waitcnt vmcnt(5)
    buffer_load_dwordx4 v[232:235], v244, s[32:35], 0 offen offset:2048 nt
    s_waitcnt vmcnt(5)
    buffer_load_dwordx4 v[236:239], v244, s[32:35], 0 offen offset:3072 nt
    v_mov_b32 v4, 0
    v_mov_b32 v5, 4
    v_mov_b32 v6, 0xff800000
    v_mov_b32 v7, 0
    v_mov_b32 v240, 0xff800000
    v_mov_b32 v8, 0
    v_mov_b32 v9, 0
    v_mov_b32 v10, 0
    v_mov_b32 v11, 0
    v_mov_b32 v12, 0
    v_mov_b32 v13, 0
    v_mov_b32 v14, 0
    v_mov_b32 v15, 0
    s_mov_b32 s48, 0xcccccccc
    s_mov_b32 s49, 0xcccccccc
    s_mov_b32 s50, 0xaaaaaaaa
    s_mov_b32 s51, 0xaaaaaaaa
    v_and_b32 v36, 0xf0, v1
    s_and_b32 s54, s3, 1
    s_lshl_b32 s54, s54, 8
    v_add_u32 v36, s54, v36
    s_mov_b32 s60, 16
    s_mov_b32 s61, 4
    s_barrier
    ds_read_b128 v[16:19], v36 offset:18432
    s_waitcnt lgkmcnt(0)
    s_waitcnt vmcnt(47)
    v_dot2_f32_bf16 v20, v48, v16, 0
    v_dot2_f32_bf16 v20, v49, v17, v20
    v_dot2_f32_bf16 v20, v50, v18, v20
    v_dot2_f32_bf16 v20, v51, v19, v20
    buffer_load_dwordx4 v[48:51], v241, s[36:39], 0 offen offset:0 nt
    s_waitcnt vmcnt(47)
    v_dot2_f32_bf16 v21, v52, v16, 0
    v_dot2_f32_bf16 v21, v53, v17, v21
    v_dot2_f32_bf16 v21, v54, v18, v21
    v_dot2_f32_bf16 v21, v55, v19, v21
    buffer_load_dwordx4 v[52:55], v241, s[36:39], 0 offen offset:1024 nt
    s_waitcnt vmcnt(47)
    v_dot2_f32_bf16 v22, v56, v16, 0
    v_dot2_f32_bf16 v22, v57, v17, v22
    v_dot2_f32_bf16 v22, v58, v18, v22
    v_dot2_f32_bf16 v22, v59, v19, v22
    buffer_load_dwordx4 v[56:59], v241, s[36:39], 0 offen offset:2048 nt
    s_waitcnt vmcnt(47)
    v_dot2_f32_bf16 v23, v60, v16, 0
    v_dot2_f32_bf16 v23, v61, v17, v23
    v_dot2_f32_bf16 v23, v62, v18, v23
    v_dot2_f32_bf16 v23, v63, v19, v23
    buffer_load_dwordx4 v[60:63], v241, s[36:39], 0 offen offset:3072 nt
    s_waitcnt vmcnt(47)
    v_dot2_f32_bf16 v24, v64, v16, 0
    v_dot2_f32_bf16 v24, v65, v17, v24
    v_dot2_f32_bf16 v24, v66, v18, v24
    v_dot2_f32_bf16 v24, v67, v19, v24
    buffer_load_dwordx4 v[64:67], v242, s[36:39], 0 offen offset:0 nt
    s_waitcnt vmcnt(47)
    v_dot2_f32_bf16 v25, v68, v16, 0
    v_dot2_f32_bf16 v25, v69, v17, v25
    v_dot2_f32_bf16 v25, v70, v18, v25
    v_dot2_f32_bf16 v25, v71, v19, v25
    buffer_load_dwordx4 v[68:71], v242, s[36:39], 0 offen offset:1024 nt
    s_waitcnt vmcnt(47)
    v_dot2_f32_bf16 v26, v72, v16, 0
    v_dot2_f32_bf16 v26, v73, v17, v26
    v_dot2_f32_bf16 v26, v74, v18, v26
    v_dot2_f32_bf16 v26, v75, v19, v26
    buffer_load_dwordx4 v[72:75], v242, s[36:39], 0 offen offset:2048 nt
    s_waitcnt vmcnt(47)
    v_dot2_f32_bf16 v27, v76, v16, 0
    v_dot2_f32_bf16 v27, v77, v17, v27
    v_dot2_f32_bf16 v27, v78, v18, v27
    v_dot2_f32_bf16 v27, v79, v19, v27
    buffer_load_dwordx4 v[76:79], v242, s[36:39], 0 offen offset:3072 nt
    s_waitcnt vmcnt(47)
    v_dot2_f32_bf16 v28, v80, v16, 0
    v_dot2_f32_bf16 v28, v81, v17, v28
    v_dot2_f32_bf16 v28, v82, v18, v28
    v_dot2_f32_bf16 v28, v83, v19, v28
    buffer_load_dwordx4 v[80:83], v243, s[36:39], 0 offen offset:0 nt
    s_waitcnt vmcnt(47)
    v_dot2_f32_bf16 v29, v84, v16, 0
    v_dot2_f32_bf16 v29, v85, v17, v29
    v_dot2_f32_bf16 v29, v86, v18, v29
    v_dot2_f32_bf16 v29, v87, v19, v29
    buffer_load_dwordx4 v[84:87], v243, s[36:39], 0 offen offset:1024 nt
    s_waitcnt vmcnt(47)
    v_dot2_f32_bf16 v30, v88, v16, 0
    v_dot2_f32_bf16 v30, v89, v17, v30
    v_dot2_f32_bf16 v30, v90, v18, v30
    v_dot2_f32_bf16 v30, v91, v19, v30
    buffer_load_dwordx4 v[88:91], v243, s[36:39], 0 offen offset:2048 nt
    s_waitcnt vmcnt(47)
    v_dot2_f32_bf16 v31, v92, v16, 0
    v_dot2_f32_bf16 v31, v93, v17, v31
    v_dot2_f32_bf16 v31, v94, v18, v31
    v_dot2_f32_bf16 v31, v95, v19, v31
    buffer_load_dwordx4 v[92:95], v243, s[36:39], 0 offen offset:3072 nt
    s_waitcnt vmcnt(47)
    v_dot2_f32_bf16 v32, v96, v16, 0
    v_dot2_f32_bf16 v32, v97, v17, v32
    v_dot2_f32_bf16 v32, v98, v18, v32
    v_dot2_f32_bf16 v32, v99, v19, v32
    buffer_load_dwordx4 v[96:99], v244, s[36:39], 0 offen offset:0 nt
    s_waitcnt vmcnt(47)
    v_dot2_f32_bf16 v33, v100, v16, 0
    v_dot2_f32_bf16 v33, v101, v17, v33
    v_dot2_f32_bf16 v33, v102, v18, v33
    v_dot2_f32_bf16 v33, v103, v19, v33
    buffer_load_dwordx4 v[100:103], v244, s[36:39], 0 offen offset:1024 nt
    s_waitcnt vmcnt(47)
    v_dot2_f32_bf16 v34, v104, v16, 0
    v_dot2_f32_bf16 v34, v105, v17, v34
    v_dot2_f32_bf16 v34, v106, v18, v34
    v_dot2_f32_bf16 v34, v107, v19, v34
    buffer_load_dwordx4 v[104:107], v244, s[36:39], 0 offen offset:2048 nt
    s_waitcnt vmcnt(47)
    v_dot2_f32_bf16 v35, v108, v16, 0
    v_dot2_f32_bf16 v35, v109, v17, v35
    v_dot2_f32_bf16 v35, v110, v18, v35
    v_dot2_f32_bf16 v35, v111, v19, v35
    buffer_load_dwordx4 v[108:111], v244, s[36:39], 0 offen offset:3072 nt
    v_add_f32_dpp v20, v20, v20 row_ror:8 row_mask:0xf bank_mask:0x3
    v_add_f32_dpp v20, v28, v28 row_ror:8 row_mask:0xf bank_mask:0xc
    v_add_f32_dpp v21, v21, v21 row_ror:8 row_mask:0xf bank_mask:0x3
    v_add_f32_dpp v21, v29, v29 row_ror:8 row_mask:0xf bank_mask:0xc
    v_add_f32_dpp v22, v22, v22 row_ror:8 row_mask:0xf bank_mask:0x3
    v_add_f32_dpp v22, v30, v30 row_ror:8 row_mask:0xf bank_mask:0xc
    v_add_f32_dpp v23, v23, v23 row_ror:8 row_mask:0xf bank_mask:0x3
    v_add_f32_dpp v23, v31, v31 row_ror:8 row_mask:0xf bank_mask:0xc
    v_add_f32_dpp v24, v24, v24 row_ror:8 row_mask:0xf bank_mask:0x3
    v_add_f32_dpp v24, v32, v32 row_ror:8 row_mask:0xf bank_mask:0xc
    v_add_f32_dpp v25, v25, v25 row_ror:8 row_mask:0xf bank_mask:0x3
    v_add_f32_dpp v25, v33, v33 row_ror:8 row_mask:0xf bank_mask:0xc
    v_add_f32_dpp v26, v26, v26 row_ror:8 row_mask:0xf bank_mask:0x3
    v_add_f32_dpp v26, v34, v34 row_ror:8 row_mask:0xf bank_mask:0xc
    v_add_f32_dpp v27, v27, v27 row_ror:8 row_mask:0xf bank_mask:0x3
    v_add_f32_dpp v27, v35, v35 row_ror:8 row_mask:0xf bank_mask:0xc
    v_add_f32_dpp v20, v20, v20 row_half_mirror row_mask:0xf bank_mask:0x5
    v_add_f32_dpp v20, v24, v24 row_half_mirror row_mask:0xf bank_mask:0xa
    v_add_f32_dpp v21, v21, v21 row_half_mirror row_mask:0xf bank_mask:0x5
    v_add_f32_dpp v21, v25, v25 row_half_mirror row_mask:0xf bank_mask:0xa
    v_add_f32_dpp v22, v22, v22 row_half_mirror row_mask:0xf bank_mask:0x5
    v_add_f32_dpp v22, v26, v26 row_half_mirror row_mask:0xf bank_mask:0xa
    v_add_f32_dpp v23, v23, v23 row_half_mirror row_mask:0xf bank_mask:0x5
    v_add_f32_dpp v23, v27, v27 row_half_mirror row_mask:0xf bank_mask:0xa
    v_add_f32_dpp v36, v20, v20 quad_perm:[3,2,1,0] row_mask:0xf bank_mask:0xf
    v_add_f32_dpp v37, v22, v22 quad_perm:[3,2,1,0] row_mask:0xf bank_mask:0xf
    v_add_f32_dpp v38, v21, v21 quad_perm:[3,2,1,0] row_mask:0xf bank_mask:0xf
    v_add_f32_dpp v39, v23, v23 quad_perm:[3,2,1,0] row_mask:0xf bank_mask:0xf
    v_cndmask_b32 v20, v36, v37, s[48:49]
    v_cndmask_b32 v21, v38, v39, s[48:49]
    s_nop 1
    v_add_f32_dpp v36, v20, v20 quad_perm:[1,0,3,2] row_mask:0xf bank_mask:0xf
    v_add_f32_dpp v37, v21, v21 quad_perm:[1,0,3,2] row_mask:0xf bank_mask:0xf
    v_cndmask_b32 v20, v36, v37, s[50:51]
    v_cvt_pk_bf16_f32 v20, v20, v20
    v_and_b32 v20, s43, v20
    v_mul_f32 v20, 0x3db504f3, v20
    v_cvt_pk_bf16_f32 v20, v20, v20
    v_and_b32 v20, s43, v20
    v_max_f32 v21, v20, v6
    s_nop 1
    v_max_f32_dpp v21, v21, v21 row_ror:8 row_mask:0xf bank_mask:0xf
    s_nop 1
    v_max_f32_dpp v21, v21, v21 row_half_mirror row_mask:0xf bank_mask:0xf
    s_nop 1
    v_max_f32_dpp v21, v21, v21 quad_perm:[3,2,1,0] row_mask:0xf bank_mask:0xf
    s_nop 1
    v_max_f32_dpp v21, v21, v21 quad_perm:[1,0,3,2] row_mask:0xf bank_mask:0xf
    v_sub_f32 v22, v6, v21
    v_sub_f32 v23, v20, v21
    v_mul_f32 v22, 0x3fb8aa3b, v22
    v_mul_f32 v23, 0x3fb8aa3b, v23
    v_exp_f32 v22, v22
    v_exp_f32 v23, v23
    v_mov_b32 v6, v21
    v_cvt_pk_bf16_f32 v25, v4, v23
    v_cvt_pk_bf16_f32 v24, v23, v4
    v_fma_f32 v7, v7, v22, v25
    v_mul_f32 v8, v8, v22
    v_mul_f32 v9, v9, v22
    v_mul_f32 v10, v10, v22
    v_mul_f32 v11, v11, v22
    v_mul_f32 v12, v12, v22
    v_mul_f32 v13, v13, v22
    v_mul_f32 v14, v14, v22
    v_mul_f32 v15, v15, v22
    s_waitcnt vmcnt(32)
    v_dot2c_f32_bf16_dpp v8, v24, v112 row_newbcast:0 row_mask:0xf bank_mask:0xf
    v_dot2c_f32_bf16_dpp v9, v25, v112 row_newbcast:0 row_mask:0xf bank_mask:0xf
    v_dot2c_f32_bf16_dpp v10, v24, v113 row_newbcast:0 row_mask:0xf bank_mask:0xf
    v_dot2c_f32_bf16_dpp v11, v25, v113 row_newbcast:0 row_mask:0xf bank_mask:0xf
    v_dot2c_f32_bf16_dpp v12, v24, v114 row_newbcast:0 row_mask:0xf bank_mask:0xf
    v_dot2c_f32_bf16_dpp v13, v25, v114 row_newbcast:0 row_mask:0xf bank_mask:0xf
    v_dot2c_f32_bf16_dpp v14, v24, v115 row_newbcast:0 row_mask:0xf bank_mask:0xf
    v_dot2c_f32_bf16_dpp v15, v25, v115 row_newbcast:0 row_mask:0xf bank_mask:0xf
    v_dot2c_f32_bf16_dpp v8, v24, v116 row_newbcast:1 row_mask:0xf bank_mask:0xf
    v_dot2c_f32_bf16_dpp v9, v25, v116 row_newbcast:1 row_mask:0xf bank_mask:0xf
    v_dot2c_f32_bf16_dpp v10, v24, v117 row_newbcast:1 row_mask:0xf bank_mask:0xf
    v_dot2c_f32_bf16_dpp v11, v25, v117 row_newbcast:1 row_mask:0xf bank_mask:0xf
    v_dot2c_f32_bf16_dpp v12, v24, v118 row_newbcast:1 row_mask:0xf bank_mask:0xf
    v_dot2c_f32_bf16_dpp v13, v25, v118 row_newbcast:1 row_mask:0xf bank_mask:0xf
    v_dot2c_f32_bf16_dpp v14, v24, v119 row_newbcast:1 row_mask:0xf bank_mask:0xf
    v_dot2c_f32_bf16_dpp v15, v25, v119 row_newbcast:1 row_mask:0xf bank_mask:0xf
    v_dot2c_f32_bf16_dpp v8, v24, v120 row_newbcast:2 row_mask:0xf bank_mask:0xf
    v_dot2c_f32_bf16_dpp v9, v25, v120 row_newbcast:2 row_mask:0xf bank_mask:0xf
    v_dot2c_f32_bf16_dpp v10, v24, v121 row_newbcast:2 row_mask:0xf bank_mask:0xf
    v_dot2c_f32_bf16_dpp v11, v25, v121 row_newbcast:2 row_mask:0xf bank_mask:0xf
    v_dot2c_f32_bf16_dpp v12, v24, v122 row_newbcast:2 row_mask:0xf bank_mask:0xf
    v_dot2c_f32_bf16_dpp v13, v25, v122 row_newbcast:2 row_mask:0xf bank_mask:0xf
    v_dot2c_f32_bf16_dpp v14, v24, v123 row_newbcast:2 row_mask:0xf bank_mask:0xf
    v_dot2c_f32_bf16_dpp v15, v25, v123 row_newbcast:2 row_mask:0xf bank_mask:0xf
    v_dot2c_f32_bf16_dpp v8, v24, v124 row_newbcast:3 row_mask:0xf bank_mask:0xf
    v_dot2c_f32_bf16_dpp v9, v25, v124 row_newbcast:3 row_mask:0xf bank_mask:0xf
    v_dot2c_f32_bf16_dpp v10, v24, v125 row_newbcast:3 row_mask:0xf bank_mask:0xf
    v_dot2c_f32_bf16_dpp v11, v25, v125 row_newbcast:3 row_mask:0xf bank_mask:0xf
    v_dot2c_f32_bf16_dpp v12, v24, v126 row_newbcast:3 row_mask:0xf bank_mask:0xf
    v_dot2c_f32_bf16_dpp v13, v25, v126 row_newbcast:3 row_mask:0xf bank_mask:0xf
    v_dot2c_f32_bf16_dpp v14, v24, v127 row_newbcast:3 row_mask:0xf bank_mask:0xf
    v_dot2c_f32_bf16_dpp v15, v25, v127 row_newbcast:3 row_mask:0xf bank_mask:0xf
    v_dot2c_f32_bf16_dpp v8, v24, v128 row_newbcast:4 row_mask:0xf bank_mask:0xf
    v_dot2c_f32_bf16_dpp v9, v25, v128 row_newbcast:4 row_mask:0xf bank_mask:0xf
    v_dot2c_f32_bf16_dpp v10, v24, v129 row_newbcast:4 row_mask:0xf bank_mask:0xf
    v_dot2c_f32_bf16_dpp v11, v25, v129 row_newbcast:4 row_mask:0xf bank_mask:0xf
    v_dot2c_f32_bf16_dpp v12, v24, v130 row_newbcast:4 row_mask:0xf bank_mask:0xf
    v_dot2c_f32_bf16_dpp v13, v25, v130 row_newbcast:4 row_mask:0xf bank_mask:0xf
    v_dot2c_f32_bf16_dpp v14, v24, v131 row_newbcast:4 row_mask:0xf bank_mask:0xf
    v_dot2c_f32_bf16_dpp v15, v25, v131 row_newbcast:4 row_mask:0xf bank_mask:0xf
    v_dot2c_f32_bf16_dpp v8, v24, v132 row_newbcast:5 row_mask:0xf bank_mask:0xf
    v_dot2c_f32_bf16_dpp v9, v25, v132 row_newbcast:5 row_mask:0xf bank_mask:0xf
    v_dot2c_f32_bf16_dpp v10, v24, v133 row_newbcast:5 row_mask:0xf bank_mask:0xf
    v_dot2c_f32_bf16_dpp v11, v25, v133 row_newbcast:5 row_mask:0xf bank_mask:0xf
    v_dot2c_f32_bf16_dpp v12, v24, v134 row_newbcast:5 row_mask:0xf bank_mask:0xf
    v_dot2c_f32_bf16_dpp v13, v25, v134 row_newbcast:5 row_mask:0xf bank_mask:0xf
    v_dot2c_f32_bf16_dpp v14, v24, v135 row_newbcast:5 row_mask:0xf bank_mask:0xf
    v_dot2c_f32_bf16_dpp v15, v25, v135 row_newbcast:5 row_mask:0xf bank_mask:0xf
    v_dot2c_f32_bf16_dpp v8, v24, v136 row_newbcast:6 row_mask:0xf bank_mask:0xf
    v_dot2c_f32_bf16_dpp v9, v25, v136 row_newbcast:6 row_mask:0xf bank_mask:0xf
    v_dot2c_f32_bf16_dpp v10, v24, v137 row_newbcast:6 row_mask:0xf bank_mask:0xf
    v_dot2c_f32_bf16_dpp v11, v25, v137 row_newbcast:6 row_mask:0xf bank_mask:0xf
    v_dot2c_f32_bf16_dpp v12, v24, v138 row_newbcast:6 row_mask:0xf bank_mask:0xf
    v_dot2c_f32_bf16_dpp v13, v25, v138 row_newbcast:6 row_mask:0xf bank_mask:0xf
    v_dot2c_f32_bf16_dpp v14, v24, v139 row_newbcast:6 row_mask:0xf bank_mask:0xf
    v_dot2c_f32_bf16_dpp v15, v25, v139 row_newbcast:6 row_mask:0xf bank_mask:0xf
    v_dot2c_f32_bf16_dpp v8, v24, v140 row_newbcast:7 row_mask:0xf bank_mask:0xf
    v_dot2c_f32_bf16_dpp v9, v25, v140 row_newbcast:7 row_mask:0xf bank_mask:0xf
    v_dot2c_f32_bf16_dpp v10, v24, v141 row_newbcast:7 row_mask:0xf bank_mask:0xf
    v_dot2c_f32_bf16_dpp v11, v25, v141 row_newbcast:7 row_mask:0xf bank_mask:0xf
    v_dot2c_f32_bf16_dpp v12, v24, v142 row_newbcast:7 row_mask:0xf bank_mask:0xf
    v_dot2c_f32_bf16_dpp v13, v25, v142 row_newbcast:7 row_mask:0xf bank_mask:0xf
    v_dot2c_f32_bf16_dpp v14, v24, v143 row_newbcast:7 row_mask:0xf bank_mask:0xf
    v_dot2c_f32_bf16_dpp v15, v25, v143 row_newbcast:7 row_mask:0xf bank_mask:0xf
    v_dot2c_f32_bf16_dpp v8, v24, v144 row_newbcast:8 row_mask:0xf bank_mask:0xf
    v_dot2c_f32_bf16_dpp v9, v25, v144 row_newbcast:8 row_mask:0xf bank_mask:0xf
    v_dot2c_f32_bf16_dpp v10, v24, v145 row_newbcast:8 row_mask:0xf bank_mask:0xf
    v_dot2c_f32_bf16_dpp v11, v25, v145 row_newbcast:8 row_mask:0xf bank_mask:0xf
    v_dot2c_f32_bf16_dpp v12, v24, v146 row_newbcast:8 row_mask:0xf bank_mask:0xf
    v_dot2c_f32_bf16_dpp v13, v25, v146 row_newbcast:8 row_mask:0xf bank_mask:0xf
    v_dot2c_f32_bf16_dpp v14, v24, v147 row_newbcast:8 row_mask:0xf bank_mask:0xf
    v_dot2c_f32_bf16_dpp v15, v25, v147 row_newbcast:8 row_mask:0xf bank_mask:0xf
    v_dot2c_f32_bf16_dpp v8, v24, v148 row_newbcast:9 row_mask:0xf bank_mask:0xf
    v_dot2c_f32_bf16_dpp v9, v25, v148 row_newbcast:9 row_mask:0xf bank_mask:0xf
    v_dot2c_f32_bf16_dpp v10, v24, v149 row_newbcast:9 row_mask:0xf bank_mask:0xf
    v_dot2c_f32_bf16_dpp v11, v25, v149 row_newbcast:9 row_mask:0xf bank_mask:0xf
    v_dot2c_f32_bf16_dpp v12, v24, v150 row_newbcast:9 row_mask:0xf bank_mask:0xf
    v_dot2c_f32_bf16_dpp v13, v25, v150 row_newbcast:9 row_mask:0xf bank_mask:0xf
    v_dot2c_f32_bf16_dpp v14, v24, v151 row_newbcast:9 row_mask:0xf bank_mask:0xf
    v_dot2c_f32_bf16_dpp v15, v25, v151 row_newbcast:9 row_mask:0xf bank_mask:0xf
    v_dot2c_f32_bf16_dpp v8, v24, v152 row_newbcast:10 row_mask:0xf bank_mask:0xf
    v_dot2c_f32_bf16_dpp v9, v25, v152 row_newbcast:10 row_mask:0xf bank_mask:0xf
    v_dot2c_f32_bf16_dpp v10, v24, v153 row_newbcast:10 row_mask:0xf bank_mask:0xf
    v_dot2c_f32_bf16_dpp v11, v25, v153 row_newbcast:10 row_mask:0xf bank_mask:0xf
    v_dot2c_f32_bf16_dpp v12, v24, v154 row_newbcast:10 row_mask:0xf bank_mask:0xf
    v_dot2c_f32_bf16_dpp v13, v25, v154 row_newbcast:10 row_mask:0xf bank_mask:0xf
    v_dot2c_f32_bf16_dpp v14, v24, v155 row_newbcast:10 row_mask:0xf bank_mask:0xf
    v_dot2c_f32_bf16_dpp v15, v25, v155 row_newbcast:10 row_mask:0xf bank_mask:0xf
    v_dot2c_f32_bf16_dpp v8, v24, v156 row_newbcast:11 row_mask:0xf bank_mask:0xf
    v_dot2c_f32_bf16_dpp v9, v25, v156 row_newbcast:11 row_mask:0xf bank_mask:0xf
    v_dot2c_f32_bf16_dpp v10, v24, v157 row_newbcast:11 row_mask:0xf bank_mask:0xf
    v_dot2c_f32_bf16_dpp v11, v25, v157 row_newbcast:11 row_mask:0xf bank_mask:0xf
    v_dot2c_f32_bf16_dpp v12, v24, v158 row_newbcast:11 row_mask:0xf bank_mask:0xf
    v_dot2c_f32_bf16_dpp v13, v25, v158 row_newbcast:11 row_mask:0xf bank_mask:0xf
    v_dot2c_f32_bf16_dpp v14, v24, v159 row_newbcast:11 row_mask:0xf bank_mask:0xf
    v_dot2c_f32_bf16_dpp v15, v25, v159 row_newbcast:11 row_mask:0xf bank_mask:0xf
    v_dot2c_f32_bf16_dpp v8, v24, v160 row_newbcast:12 row_mask:0xf bank_mask:0xf
    v_dot2c_f32_bf16_dpp v9, v25, v160 row_newbcast:12 row_mask:0xf bank_mask:0xf
    v_dot2c_f32_bf16_dpp v10, v24, v161 row_newbcast:12 row_mask:0xf bank_mask:0xf
    v_dot2c_f32_bf16_dpp v11, v25, v161 row_newbcast:12 row_mask:0xf bank_mask:0xf
    v_dot2c_f32_bf16_dpp v12, v24, v162 row_newbcast:12 row_mask:0xf bank_mask:0xf
    v_dot2c_f32_bf16_dpp v13, v25, v162 row_newbcast:12 row_mask:0xf bank_mask:0xf
    v_dot2c_f32_bf16_dpp v14, v24, v163 row_newbcast:12 row_mask:0xf bank_mask:0xf
    v_dot2c_f32_bf16_dpp v15, v25, v163 row_newbcast:12 row_mask:0xf bank_mask:0xf
    v_dot2c_f32_bf16_dpp v8, v24, v164 row_newbcast:13 row_mask:0xf bank_mask:0xf
    v_dot2c_f32_bf16_dpp v9, v25, v164 row_newbcast:13 row_mask:0xf bank_mask:0xf
    v_dot2c_f32_bf16_dpp v10, v24, v165 row_newbcast:13 row_mask:0xf bank_mask:0xf
    v_dot2c_f32_bf16_dpp v11, v25, v165 row_newbcast:13 row_mask:0xf bank_mask:0xf
    v_dot2c_f32_bf16_dpp v12, v24, v166 row_newbcast:13 row_mask:0xf bank_mask:0xf
    v_dot2c_f32_bf16_dpp v13, v25, v166 row_newbcast:13 row_mask:0xf bank_mask:0xf
    v_dot2c_f32_bf16_dpp v14, v24, v167 row_newbcast:13 row_mask:0xf bank_mask:0xf
    v_dot2c_f32_bf16_dpp v15, v25, v167 row_newbcast:13 row_mask:0xf bank_mask:0xf
    v_dot2c_f32_bf16_dpp v8, v24, v168 row_newbcast:14 row_mask:0xf bank_mask:0xf
    v_dot2c_f32_bf16_dpp v9, v25, v168 row_newbcast:14 row_mask:0xf bank_mask:0xf
    v_dot2c_f32_bf16_dpp v10, v24, v169 row_newbcast:14 row_mask:0xf bank_mask:0xf
    v_dot2c_f32_bf16_dpp v11, v25, v169 row_newbcast:14 row_mask:0xf bank_mask:0xf
    v_dot2c_f32_bf16_dpp v12, v24, v170 row_newbcast:14 row_mask:0xf bank_mask:0xf
    v_dot2c_f32_bf16_dpp v13, v25, v170 row_newbcast:14 row_mask:0xf bank_mask:0xf
    v_dot2c_f32_bf16_dpp v14, v24, v171 row_newbcast:14 row_mask:0xf bank_mask:0xf
    v_dot2c_f32_bf16_dpp v15, v25, v171 row_newbcast:14 row_mask:0xf bank_mask:0xf
    v_dot2c_f32_bf16_dpp v8, v24, v172 row_newbcast:15 row_mask:0xf bank_mask:0xf
    v_dot2c_f32_bf16_dpp v9, v25, v172 row_newbcast:15 row_mask:0xf bank_mask:0xf
    v_dot2c_f32_bf16_dpp v10, v24, v173 row_newbcast:15 row_mask:0xf bank_mask:0xf
    v_dot2c_f32_bf16_dpp v11, v25, v173 row_newbcast:15 row_mask:0xf bank_mask:0xf
    v_dot2c_f32_bf16_dpp v12, v24, v174 row_newbcast:15 row_mask:0xf bank_mask:0xf
    v_dot2c_f32_bf16_dpp v13, v25, v174 row_newbcast:15 row_mask:0xf bank_mask:0xf
    v_dot2c_f32_bf16_dpp v14, v24, v175 row_newbcast:15 row_mask:0xf bank_mask:0xf
    v_dot2c_f32_bf16_dpp v15, v25, v175 row_newbcast:15 row_mask:0xf bank_mask:0xf
    v_add_u32 v44, 131072, v241
    v_add_u32 v45, 4096, v44
    v_add_u32 v46, 8192, v44
    v_add_u32 v47, 12288, v44
    s_waitcnt vmcnt(16)
    v_dot2_f32_bf16 v20, v176, v16, 0
    v_dot2_f32_bf16 v20, v177, v17, v20
    v_dot2_f32_bf16 v20, v178, v18, v20
    v_dot2_f32_bf16 v20, v179, v19, v20
    v_dot2_f32_bf16 v21, v180, v16, 0
    v_dot2_f32_bf16 v21, v181, v17, v21
    v_dot2_f32_bf16 v21, v182, v18, v21
    v_dot2_f32_bf16 v21, v183, v19, v21
    v_dot2_f32_bf16 v22, v184, v16, 0
    v_dot2_f32_bf16 v22, v185, v17, v22
    v_dot2_f32_bf16 v22, v186, v18, v22
    v_dot2_f32_bf16 v22, v187, v19, v22
    v_dot2_f32_bf16 v23, v188, v16, 0
    v_dot2_f32_bf16 v23, v189, v17, v23
    v_dot2_f32_bf16 v23, v190, v18, v23
    v_dot2_f32_bf16 v23, v191, v19, v23
    v_dot2_f32_bf16 v24, v192, v16, 0
    v_dot2_f32_bf16 v24, v193, v17, v24
    v_dot2_f32_bf16 v24, v194, v18, v24
    v_dot2_f32_bf16 v24, v195, v19, v24
    v_dot2_f32_bf16 v25, v196, v16, 0
    v_dot2_f32_bf16 v25, v197, v17, v25
    v_dot2_f32_bf16 v25, v198, v18, v25
    v_dot2_f32_bf16 v25, v199, v19, v25
    v_dot2_f32_bf16 v26, v200, v16, 0
    v_dot2_f32_bf16 v26, v201, v17, v26
    v_dot2_f32_bf16 v26, v202, v18, v26
    v_dot2_f32_bf16 v26, v203, v19, v26
    v_dot2_f32_bf16 v27, v204, v16, 0
    v_dot2_f32_bf16 v27, v205, v17, v27
    v_dot2_f32_bf16 v27, v206, v18, v27
    v_dot2_f32_bf16 v27, v207, v19, v27
    v_dot2_f32_bf16 v28, v208, v16, 0
    v_dot2_f32_bf16 v28, v209, v17, v28
    v_dot2_f32_bf16 v28, v210, v18, v28
    v_dot2_f32_bf16 v28, v211, v19, v28
    v_dot2_f32_bf16 v29, v212, v16, 0
    v_dot2_f32_bf16 v29, v213, v17, v29
    v_dot2_f32_bf16 v29, v214, v18, v29
    v_dot2_f32_bf16 v29, v215, v19, v29
    v_dot2_f32_bf16 v30, v216, v16, 0
    v_dot2_f32_bf16 v30, v217, v17, v30
    v_dot2_f32_bf16 v30, v218, v18, v30
    v_dot2_f32_bf16 v30, v219, v19, v30
    v_dot2_f32_bf16 v31, v220, v16, 0
    v_dot2_f32_bf16 v31, v221, v17, v31
    v_dot2_f32_bf16 v31, v222, v18, v31
    v_dot2_f32_bf16 v31, v223, v19, v31
    v_dot2_f32_bf16 v32, v224, v16, 0
    v_dot2_f32_bf16 v32, v225, v17, v32
    v_dot2_f32_bf16 v32, v226, v18, v32
    v_dot2_f32_bf16 v32, v227, v19, v32
    v_dot2_f32_bf16 v33, v228, v16, 0
    v_dot2_f32_bf16 v33, v229, v17, v33
    v_dot2_f32_bf16 v33, v230, v18, v33
    v_dot2_f32_bf16 v33, v231, v19, v33
    v_dot2_f32_bf16 v34, v232, v16, 0
    v_dot2_f32_bf16 v34, v233, v17, v34
    v_dot2_f32_bf16 v34, v234, v18, v34
    v_dot2_f32_bf16 v34, v235, v19, v34
    v_dot2_f32_bf16 v35, v236, v16, 0
    v_dot2_f32_bf16 v35, v237, v17, v35
    v_dot2_f32_bf16 v35, v238, v18, v35
    v_dot2_f32_bf16 v35, v239, v19, v35
    s_nop 1
    v_add_f32_dpp v20, v20, v20 row_ror:8 row_mask:0xf bank_mask:0x3
    v_add_f32_dpp v20, v28, v28 row_ror:8 row_mask:0xf bank_mask:0xc
    v_add_f32_dpp v21, v21, v21 row_ror:8 row_mask:0xf bank_mask:0x3
    v_add_f32_dpp v21, v29, v29 row_ror:8 row_mask:0xf bank_mask:0xc
    v_add_f32_dpp v22, v22, v22 row_ror:8 row_mask:0xf bank_mask:0x3
    v_add_f32_dpp v22, v30, v30 row_ror:8 row_mask:0xf bank_mask:0xc
    v_add_f32_dpp v23, v23, v23 row_ror:8 row_mask:0xf bank_mask:0x3
    v_add_f32_dpp v23, v31, v31 row_ror:8 row_mask:0xf bank_mask:0xc
    v_add_f32_dpp v24, v24, v24 row_ror:8 row_mask:0xf bank_mask:0x3
    v_add_f32_dpp v24, v32, v32 row_ror:8 row_mask:0xf bank_mask:0xc
    v_add_f32_dpp v25, v25, v25 row_ror:8 row_mask:0xf bank_mask:0x3
    v_add_f32_dpp v25, v33, v33 row_ror:8 row_mask:0xf bank_mask:0xc
    v_add_f32_dpp v26, v26, v26 row_ror:8 row_mask:0xf bank_mask:0x3
    v_add_f32_dpp v26, v34, v34 row_ror:8 row_mask:0xf bank_mask:0xc
    v_add_f32_dpp v27, v27, v27 row_ror:8 row_mask:0xf bank_mask:0x3
    v_add_f32_dpp v27, v35, v35 row_ror:8 row_mask:0xf bank_mask:0xc
    v_add_f32_dpp v20, v20, v20 row_half_mirror row_mask:0xf bank_mask:0x5
    v_add_f32_dpp v20, v24, v24 row_half_mirror row_mask:0xf bank_mask:0xa
    v_add_f32_dpp v21, v21, v21 row_half_mirror row_mask:0xf bank_mask:0x5
    v_add_f32_dpp v21, v25, v25 row_half_mirror row_mask:0xf bank_mask:0xa
    v_add_f32_dpp v22, v22, v22 row_half_mirror row_mask:0xf bank_mask:0x5
    v_add_f32_dpp v22, v26, v26 row_half_mirror row_mask:0xf bank_mask:0xa
    v_add_f32_dpp v23, v23, v23 row_half_mirror row_mask:0xf bank_mask:0x5
    v_add_f32_dpp v23, v27, v27 row_half_mirror row_mask:0xf bank_mask:0xa
    v_add_f32_dpp v36, v20, v20 quad_perm:[3,2,1,0] row_mask:0xf bank_mask:0xf
    v_add_f32_dpp v37, v22, v22 quad_perm:[3,2,1,0] row_mask:0xf bank_mask:0xf
    v_add_f32_dpp v38, v21, v21 quad_perm:[3,2,1,0] row_mask:0xf bank_mask:0xf
    v_add_f32_dpp v39, v23, v23 quad_perm:[3,2,1,0] row_mask:0xf bank_mask:0xf
    v_cndmask_b32 v20, v36, v37, s[48:49]
    v_cndmask_b32 v21, v38, v39, s[48:49]
    s_nop 1
    v_add_f32_dpp v36, v20, v20 quad_perm:[1,0,3,2] row_mask:0xf bank_mask:0xf
    v_add_f32_dpp v37, v21, v21 quad_perm:[1,0,3,2] row_mask:0xf bank_mask:0xf
    v_cndmask_b32 v20, v36, v37, s[50:51]
    v_cvt_pk_bf16_f32 v20, v20, v20
    v_and_b32 v20, s43, v20
    v_mul_f32 v20, 0x3db504f3, v20
    v_cvt_pk_bf16_f32 v20, v20, v20
    v_and_b32 v20, s43, v20
    v_max_f32 v21, v20, v6
    s_nop 1
    v_max_f32_dpp v21, v21, v21 row_ror:8 row_mask:0xf bank_mask:0xf
    s_nop 1
    v_max_f32_dpp v21, v21, v21 row_half_mirror row_mask:0xf bank_mask:0xf
    s_nop 1
    v_max_f32_dpp v21, v21, v21 quad_perm:[3,2,1,0] row_mask:0xf bank_mask:0xf
    s_nop 1
    v_max_f32_dpp v21, v21, v21 quad_perm:[1,0,3,2] row_mask:0xf bank_mask:0xf
    v_sub_f32 v22, v6, v21
    v_sub_f32 v23, v20, v21
    v_mul_f32 v22, 0x3fb8aa3b, v22
    v_mul_f32 v23, 0x3fb8aa3b, v23
    v_exp_f32 v22, v22
    v_exp_f32 v23, v23
    v_mov_b32 v6, v21
    v_cvt_pk_bf16_f32 v25, v4, v23
    v_cvt_pk_bf16_f32 v24, v23, v4
    v_fma_f32 v7, v7, v22, v25
    v_mul_f32 v8, v8, v22
    v_mul_f32 v9, v9, v22
    v_mul_f32 v10, v10, v22
    v_mul_f32 v11, v11, v22
    v_mul_f32 v12, v12, v22
    v_mul_f32 v13, v13, v22
    v_mul_f32 v14, v14, v22
    v_mul_f32 v15, v15, v22
    s_waitcnt vmcnt(15)
    v_dot2c_f32_bf16_dpp v8, v24, v48 row_newbcast:0 row_mask:0xf bank_mask:0xf
    v_dot2c_f32_bf16_dpp v9, v25, v48 row_newbcast:0 row_mask:0xf bank_mask:0xf
    v_dot2c_f32_bf16_dpp v10, v24, v49 row_newbcast:0 row_mask:0xf bank_mask:0xf
    v_dot2c_f32_bf16_dpp v11, v25, v49 row_newbcast:0 row_mask:0xf bank_mask:0xf
    v_dot2c_f32_bf16_dpp v12, v24, v50 row_newbcast:0 row_mask:0xf bank_mask:0xf
    v_dot2c_f32_bf16_dpp v13, v25, v50 row_newbcast:0 row_mask:0xf bank_mask:0xf
    v_dot2c_f32_bf16_dpp v14, v24, v51 row_newbcast:0 row_mask:0xf bank_mask:0xf
    v_dot2c_f32_bf16_dpp v15, v25, v51 row_newbcast:0 row_mask:0xf bank_mask:0xf
    buffer_load_dwordx4 v[48:51], v44, s[32:35], 0 offen offset:0 nt
    s_waitcnt vmcnt(15)
    v_dot2c_f32_bf16_dpp v8, v24, v52 row_newbcast:1 row_mask:0xf bank_mask:0xf
    v_dot2c_f32_bf16_dpp v9, v25, v52 row_newbcast:1 row_mask:0xf bank_mask:0xf
    v_dot2c_f32_bf16_dpp v10, v24, v53 row_newbcast:1 row_mask:0xf bank_mask:0xf
    v_dot2c_f32_bf16_dpp v11, v25, v53 row_newbcast:1 row_mask:0xf bank_mask:0xf
    v_dot2c_f32_bf16_dpp v12, v24, v54 row_newbcast:1 row_mask:0xf bank_mask:0xf
    v_dot2c_f32_bf16_dpp v13, v25, v54 row_newbcast:1 row_mask:0xf bank_mask:0xf
    v_dot2c_f32_bf16_dpp v14, v24, v55 row_newbcast:1 row_mask:0xf bank_mask:0xf
    v_dot2c_f32_bf16_dpp v15, v25, v55 row_newbcast:1 row_mask:0xf bank_mask:0xf
    buffer_load_dwordx4 v[52:55], v44, s[32:35], 0 offen offset:1024 nt
    s_waitcnt vmcnt(15)
    v_dot2c_f32_bf16_dpp v8, v24, v56 row_newbcast:2 row_mask:0xf bank_mask:0xf
    v_dot2c_f32_bf16_dpp v9, v25, v56 row_newbcast:2 row_mask:0xf bank_mask:0xf
    v_dot2c_f32_bf16_dpp v10, v24, v57 row_newbcast:2 row_mask:0xf bank_mask:0xf
    v_dot2c_f32_bf16_dpp v11, v25, v57 row_newbcast:2 row_mask:0xf bank_mask:0xf
    v_dot2c_f32_bf16_dpp v12, v24, v58 row_newbcast:2 row_mask:0xf bank_mask:0xf
    v_dot2c_f32_bf16_dpp v13, v25, v58 row_newbcast:2 row_mask:0xf bank_mask:0xf
    v_dot2c_f32_bf16_dpp v14, v24, v59 row_newbcast:2 row_mask:0xf bank_mask:0xf
    v_dot2c_f32_bf16_dpp v15, v25, v59 row_newbcast:2 row_mask:0xf bank_mask:0xf
    buffer_load_dwordx4 v[56:59], v44, s[32:35], 0 offen offset:2048 nt
    s_waitcnt vmcnt(15)
    v_dot2c_f32_bf16_dpp v8, v24, v60 row_newbcast:3 row_mask:0xf bank_mask:0xf
    v_dot2c_f32_bf16_dpp v9, v25, v60 row_newbcast:3 row_mask:0xf bank_mask:0xf
    v_dot2c_f32_bf16_dpp v10, v24, v61 row_newbcast:3 row_mask:0xf bank_mask:0xf
    v_dot2c_f32_bf16_dpp v11, v25, v61 row_newbcast:3 row_mask:0xf bank_mask:0xf
    v_dot2c_f32_bf16_dpp v12, v24, v62 row_newbcast:3 row_mask:0xf bank_mask:0xf
    v_dot2c_f32_bf16_dpp v13, v25, v62 row_newbcast:3 row_mask:0xf bank_mask:0xf
    v_dot2c_f32_bf16_dpp v14, v24, v63 row_newbcast:3 row_mask:0xf bank_mask:0xf
    v_dot2c_f32_bf16_dpp v15, v25, v63 row_newbcast:3 row_mask:0xf bank_mask:0xf
    buffer_load_dwordx4 v[60:63], v44, s[32:35], 0 offen offset:3072 nt
    s_waitcnt vmcnt(15)
    v_dot2c_f32_bf16_dpp v8, v24, v64 row_newbcast:4 row_mask:0xf bank_mask:0xf
    v_dot2c_f32_bf16_dpp v9, v25, v64 row_newbcast:4 row_mask:0xf bank_mask:0xf
    v_dot2c_f32_bf16_dpp v10, v24, v65 row_newbcast:4 row_mask:0xf bank_mask:0xf
    v_dot2c_f32_bf16_dpp v11, v25, v65 row_newbcast:4 row_mask:0xf bank_mask:0xf
    v_dot2c_f32_bf16_dpp v12, v24, v66 row_newbcast:4 row_mask:0xf bank_mask:0xf
    v_dot2c_f32_bf16_dpp v13, v25, v66 row_newbcast:4 row_mask:0xf bank_mask:0xf
    v_dot2c_f32_bf16_dpp v14, v24, v67 row_newbcast:4 row_mask:0xf bank_mask:0xf
    v_dot2c_f32_bf16_dpp v15, v25, v67 row_newbcast:4 row_mask:0xf bank_mask:0xf
    buffer_load_dwordx4 v[64:67], v45, s[32:35], 0 offen offset:0 nt
    s_waitcnt vmcnt(15)
    v_dot2c_f32_bf16_dpp v8, v24, v68 row_newbcast:5 row_mask:0xf bank_mask:0xf
    v_dot2c_f32_bf16_dpp v9, v25, v68 row_newbcast:5 row_mask:0xf bank_mask:0xf
    v_dot2c_f32_bf16_dpp v10, v24, v69 row_newbcast:5 row_mask:0xf bank_mask:0xf
    v_dot2c_f32_bf16_dpp v11, v25, v69 row_newbcast:5 row_mask:0xf bank_mask:0xf
    v_dot2c_f32_bf16_dpp v12, v24, v70 row_newbcast:5 row_mask:0xf bank_mask:0xf
    v_dot2c_f32_bf16_dpp v13, v25, v70 row_newbcast:5 row_mask:0xf bank_mask:0xf
    v_dot2c_f32_bf16_dpp v14, v24, v71 row_newbcast:5 row_mask:0xf bank_mask:0xf
    v_dot2c_f32_bf16_dpp v15, v25, v71 row_newbcast:5 row_mask:0xf bank_mask:0xf
    buffer_load_dwordx4 v[68:71], v45, s[32:35], 0 offen offset:1024 nt
    s_waitcnt vmcnt(15)
    v_dot2c_f32_bf16_dpp v8, v24, v72 row_newbcast:6 row_mask:0xf bank_mask:0xf
    v_dot2c_f32_bf16_dpp v9, v25, v72 row_newbcast:6 row_mask:0xf bank_mask:0xf
    v_dot2c_f32_bf16_dpp v10, v24, v73 row_newbcast:6 row_mask:0xf bank_mask:0xf
    v_dot2c_f32_bf16_dpp v11, v25, v73 row_newbcast:6 row_mask:0xf bank_mask:0xf
    v_dot2c_f32_bf16_dpp v12, v24, v74 row_newbcast:6 row_mask:0xf bank_mask:0xf
    v_dot2c_f32_bf16_dpp v13, v25, v74 row_newbcast:6 row_mask:0xf bank_mask:0xf
    v_dot2c_f32_bf16_dpp v14, v24, v75 row_newbcast:6 row_mask:0xf bank_mask:0xf
    v_dot2c_f32_bf16_dpp v15, v25, v75 row_newbcast:6 row_mask:0xf bank_mask:0xf
    buffer_load_dwordx4 v[72:75], v45, s[32:35], 0 offen offset:2048 nt
    s_waitcnt vmcnt(15)
    v_dot2c_f32_bf16_dpp v8, v24, v76 row_newbcast:7 row_mask:0xf bank_mask:0xf
    v_dot2c_f32_bf16_dpp v9, v25, v76 row_newbcast:7 row_mask:0xf bank_mask:0xf
    v_dot2c_f32_bf16_dpp v10, v24, v77 row_newbcast:7 row_mask:0xf bank_mask:0xf
    v_dot2c_f32_bf16_dpp v11, v25, v77 row_newbcast:7 row_mask:0xf bank_mask:0xf
    v_dot2c_f32_bf16_dpp v12, v24, v78 row_newbcast:7 row_mask:0xf bank_mask:0xf
    v_dot2c_f32_bf16_dpp v13, v25, v78 row_newbcast:7 row_mask:0xf bank_mask:0xf
    v_dot2c_f32_bf16_dpp v14, v24, v79 row_newbcast:7 row_mask:0xf bank_mask:0xf
    v_dot2c_f32_bf16_dpp v15, v25, v79 row_newbcast:7 row_mask:0xf bank_mask:0xf
    buffer_load_dwordx4 v[76:79], v45, s[32:35], 0 offen offset:3072 nt
    s_waitcnt vmcnt(15)
    v_dot2c_f32_bf16_dpp v8, v24, v80 row_newbcast:8 row_mask:0xf bank_mask:0xf
    v_dot2c_f32_bf16_dpp v9, v25, v80 row_newbcast:8 row_mask:0xf bank_mask:0xf
    v_dot2c_f32_bf16_dpp v10, v24, v81 row_newbcast:8 row_mask:0xf bank_mask:0xf
    v_dot2c_f32_bf16_dpp v11, v25, v81 row_newbcast:8 row_mask:0xf bank_mask:0xf
    v_dot2c_f32_bf16_dpp v12, v24, v82 row_newbcast:8 row_mask:0xf bank_mask:0xf
    v_dot2c_f32_bf16_dpp v13, v25, v82 row_newbcast:8 row_mask:0xf bank_mask:0xf
    v_dot2c_f32_bf16_dpp v14, v24, v83 row_newbcast:8 row_mask:0xf bank_mask:0xf
    v_dot2c_f32_bf16_dpp v15, v25, v83 row_newbcast:8 row_mask:0xf bank_mask:0xf
    buffer_load_dwordx4 v[80:83], v46, s[32:35], 0 offen offset:0 nt
    s_waitcnt vmcnt(15)
    v_dot2c_f32_bf16_dpp v8, v24, v84 row_newbcast:9 row_mask:0xf bank_mask:0xf
    v_dot2c_f32_bf16_dpp v9, v25, v84 row_newbcast:9 row_mask:0xf bank_mask:0xf
    v_dot2c_f32_bf16_dpp v10, v24, v85 row_newbcast:9 row_mask:0xf bank_mask:0xf
    v_dot2c_f32_bf16_dpp v11, v25, v85 row_newbcast:9 row_mask:0xf bank_mask:0xf
    v_dot2c_f32_bf16_dpp v12, v24, v86 row_newbcast:9 row_mask:0xf bank_mask:0xf
    v_dot2c_f32_bf16_dpp v13, v25, v86 row_newbcast:9 row_mask:0xf bank_mask:0xf
    v_dot2c_f32_bf16_dpp v14, v24, v87 row_newbcast:9 row_mask:0xf bank_mask:0xf
    v_dot2c_f32_bf16_dpp v15, v25, v87 row_newbcast:9 row_mask:0xf bank_mask:0xf
    buffer_load_dwordx4 v[84:87], v46, s[32:35], 0 offen offset:1024 nt
    s_waitcnt vmcnt(15)
    v_dot2c_f32_bf16_dpp v8, v24, v88 row_newbcast:10 row_mask:0xf bank_mask:0xf
    v_dot2c_f32_bf16_dpp v9, v25, v88 row_newbcast:10 row_mask:0xf bank_mask:0xf
    v_dot2c_f32_bf16_dpp v10, v24, v89 row_newbcast:10 row_mask:0xf bank_mask:0xf
    v_dot2c_f32_bf16_dpp v11, v25, v89 row_newbcast:10 row_mask:0xf bank_mask:0xf
    v_dot2c_f32_bf16_dpp v12, v24, v90 row_newbcast:10 row_mask:0xf bank_mask:0xf
    v_dot2c_f32_bf16_dpp v13, v25, v90 row_newbcast:10 row_mask:0xf bank_mask:0xf
    v_dot2c_f32_bf16_dpp v14, v24, v91 row_newbcast:10 row_mask:0xf bank_mask:0xf
    v_dot2c_f32_bf16_dpp v15, v25, v91 row_newbcast:10 row_mask:0xf bank_mask:0xf
    buffer_load_dwordx4 v[88:91], v46, s[32:35], 0 offen offset:2048 nt
    s_waitcnt vmcnt(15)
    v_dot2c_f32_bf16_dpp v8, v24, v92 row_newbcast:11 row_mask:0xf bank_mask:0xf
    v_dot2c_f32_bf16_dpp v9, v25, v92 row_newbcast:11 row_mask:0xf bank_mask:0xf
    v_dot2c_f32_bf16_dpp v10, v24, v93 row_newbcast:11 row_mask:0xf bank_mask:0xf
    v_dot2c_f32_bf16_dpp v11, v25, v93 row_newbcast:11 row_mask:0xf bank_mask:0xf
    v_dot2c_f32_bf16_dpp v12, v24, v94 row_newbcast:11 row_mask:0xf bank_mask:0xf
    v_dot2c_f32_bf16_dpp v13, v25, v94 row_newbcast:11 row_mask:0xf bank_mask:0xf
    v_dot2c_f32_bf16_dpp v14, v24, v95 row_newbcast:11 row_mask:0xf bank_mask:0xf
    v_dot2c_f32_bf16_dpp v15, v25, v95 row_newbcast:11 row_mask:0xf bank_mask:0xf
    buffer_load_dwordx4 v[92:95], v46, s[32:35], 0 offen offset:3072 nt
    s_waitcnt vmcnt(15)
    v_dot2c_f32_bf16_dpp v8, v24, v96 row_newbcast:12 row_mask:0xf bank_mask:0xf
    v_dot2c_f32_bf16_dpp v9, v25, v96 row_newbcast:12 row_mask:0xf bank_mask:0xf
    v_dot2c_f32_bf16_dpp v10, v24, v97 row_newbcast:12 row_mask:0xf bank_mask:0xf
    v_dot2c_f32_bf16_dpp v11, v25, v97 row_newbcast:12 row_mask:0xf bank_mask:0xf
    v_dot2c_f32_bf16_dpp v12, v24, v98 row_newbcast:12 row_mask:0xf bank_mask:0xf
    v_dot2c_f32_bf16_dpp v13, v25, v98 row_newbcast:12 row_mask:0xf bank_mask:0xf
    v_dot2c_f32_bf16_dpp v14, v24, v99 row_newbcast:12 row_mask:0xf bank_mask:0xf
    v_dot2c_f32_bf16_dpp v15, v25, v99 row_newbcast:12 row_mask:0xf bank_mask:0xf
    buffer_load_dwordx4 v[96:99], v47, s[32:35], 0 offen offset:0 nt
    s_waitcnt vmcnt(15)
    v_dot2c_f32_bf16_dpp v8, v24, v100 row_newbcast:13 row_mask:0xf bank_mask:0xf
    v_dot2c_f32_bf16_dpp v9, v25, v100 row_newbcast:13 row_mask:0xf bank_mask:0xf
    v_dot2c_f32_bf16_dpp v10, v24, v101 row_newbcast:13 row_mask:0xf bank_mask:0xf
    v_dot2c_f32_bf16_dpp v11, v25, v101 row_newbcast:13 row_mask:0xf bank_mask:0xf
    v_dot2c_f32_bf16_dpp v12, v24, v102 row_newbcast:13 row_mask:0xf bank_mask:0xf
    v_dot2c_f32_bf16_dpp v13, v25, v102 row_newbcast:13 row_mask:0xf bank_mask:0xf
    v_dot2c_f32_bf16_dpp v14, v24, v103 row_newbcast:13 row_mask:0xf bank_mask:0xf
    v_dot2c_f32_bf16_dpp v15, v25, v103 row_newbcast:13 row_mask:0xf bank_mask:0xf
    buffer_load_dwordx4 v[100:103], v47, s[32:35], 0 offen offset:1024 nt
    s_waitcnt vmcnt(15)
    v_dot2c_f32_bf16_dpp v8, v24, v104 row_newbcast:14 row_mask:0xf bank_mask:0xf
    v_dot2c_f32_bf16_dpp v9, v25, v104 row_newbcast:14 row_mask:0xf bank_mask:0xf
    v_dot2c_f32_bf16_dpp v10, v24, v105 row_newbcast:14 row_mask:0xf bank_mask:0xf
    v_dot2c_f32_bf16_dpp v11, v25, v105 row_newbcast:14 row_mask:0xf bank_mask:0xf
    v_dot2c_f32_bf16_dpp v12, v24, v106 row_newbcast:14 row_mask:0xf bank_mask:0xf
    v_dot2c_f32_bf16_dpp v13, v25, v106 row_newbcast:14 row_mask:0xf bank_mask:0xf
    v_dot2c_f32_bf16_dpp v14, v24, v107 row_newbcast:14 row_mask:0xf bank_mask:0xf
    v_dot2c_f32_bf16_dpp v15, v25, v107 row_newbcast:14 row_mask:0xf bank_mask:0xf
    buffer_load_dwordx4 v[104:107], v47, s[32:35], 0 offen offset:2048 nt
    s_waitcnt vmcnt(15)
    v_dot2c_f32_bf16_dpp v8, v24, v108 row_newbcast:15 row_mask:0xf bank_mask:0xf
    v_dot2c_f32_bf16_dpp v9, v25, v108 row_newbcast:15 row_mask:0xf bank_mask:0xf
    v_dot2c_f32_bf16_dpp v10, v24, v109 row_newbcast:15 row_mask:0xf bank_mask:0xf
    v_dot2c_f32_bf16_dpp v11, v25, v109 row_newbcast:15 row_mask:0xf bank_mask:0xf
    v_dot2c_f32_bf16_dpp v12, v24, v110 row_newbcast:15 row_mask:0xf bank_mask:0xf
    v_dot2c_f32_bf16_dpp v13, v25, v110 row_newbcast:15 row_mask:0xf bank_mask:0xf
    v_dot2c_f32_bf16_dpp v14, v24, v111 row_newbcast:15 row_mask:0xf bank_mask:0xf
    v_dot2c_f32_bf16_dpp v15, v25, v111 row_newbcast:15 row_mask:0xf bank_mask:0xf
    buffer_load_dwordx4 v[108:111], v47, s[32:35], 0 offen offset:3072 nt
L_loop:
    s_mov_b64 exec, 1
    global_atomic_add v3, v4, v5, s[44:45] sc0 sc1
    s_mov_b64 exec, -1
    s_waitcnt vmcnt(16)
    v_dot2_f32_bf16 v20, v48, v16, 0
    v_dot2_f32_bf16 v20, v49, v17, v20
    v_dot2_f32_bf16 v20, v50, v18, v20
    v_dot2_f32_bf16 v20, v51, v19, v20
    buffer_load_dwordx4 v[48:51], v44, s[36:39], 0 offen offset:0 nt
    s_waitcnt vmcnt(16)
    v_dot2_f32_bf16 v21, v52, v16, 0
    v_dot2_f32_bf16 v21, v53, v17, v21
    v_dot2_f32_bf16 v21, v54, v18, v21
    v_dot2_f32_bf16 v21, v55, v19, v21
    buffer_load_dwordx4 v[52:55], v44, s[36:39], 0 offen offset:1024 nt
    s_waitcnt vmcnt(16)
    v_dot2_f32_bf16 v22, v56, v16, 0
    v_dot2_f32_bf16 v22, v57, v17, v22
    v_dot2_f32_bf16 v22, v58, v18, v22
    v_dot2_f32_bf16 v22, v59, v19, v22
    buffer_load_dwordx4 v[56:59], v44, s[36:39], 0 offen offset:2048 nt
    s_waitcnt vmcnt(16)
    v_dot2_f32_bf16 v23, v60, v16, 0
    v_dot2_f32_bf16 v23, v61, v17, v23
    v_dot2_f32_bf16 v23, v62, v18, v23
    v_dot2_f32_bf16 v23, v63, v19, v23
    buffer_load_dwordx4 v[60:63], v44, s[36:39], 0 offen offset:3072 nt
    s_waitcnt vmcnt(16)
    v_dot2_f32_bf16 v24, v64, v16, 0
    v_dot2_f32_bf16 v24, v65, v17, v24
    v_dot2_f32_bf16 v24, v66, v18, v24
    v_dot2_f32_bf16 v24, v67, v19, v24
    buffer_load_dwordx4 v[64:67], v45, s[36:39], 0 offen offset:0 nt
    s_waitcnt vmcnt(16)
    v_dot2_f32_bf16 v25, v68, v16, 0
    v_dot2_f32_bf16 v25, v69, v17, v25
    v_dot2_f32_bf16 v25, v70, v18, v25
    v_dot2_f32_bf16 v25, v71, v19, v25
    buffer_load_dwordx4 v[68:71], v45, s[36:39], 0 offen offset:1024 nt
    s_waitcnt vmcnt(16)
    v_dot2_f32_bf16 v26, v72, v16, 0
    v_dot2_f32_bf16 v26, v73, v17, v26
    v_dot2_f32_bf16 v26, v74, v18, v26
    v_dot2_f32_bf16 v26, v75, v19, v26
    buffer_load_dwordx4 v[72:75], v45, s[36:39], 0 offen offset:2048 nt
    s_waitcnt vmcnt(16)
    v_dot2_f32_bf16 v27, v76, v16, 0
    v_dot2_f32_bf16 v27, v77, v17, v27
    v_dot2_f32_bf16 v27, v78, v18, v27
    v_dot2_f32_bf16 v27, v79, v19, v27
    buffer_load_dwordx4 v[76:79], v45, s[36:39], 0 offen offset:3072 nt
    s_waitcnt vmcnt(16)
    v_dot2_f32_bf16 v28, v80, v16, 0
    v_dot2_f32_bf16 v28, v81, v17, v28
    v_dot2_f32_bf16 v28, v82, v18, v28
    v_dot2_f32_bf16 v28, v83, v19, v28
    buffer_load_dwordx4 v[80:83], v46, s[36:39], 0 offen offset:0 nt
    s_waitcnt vmcnt(16)
    v_dot2_f32_bf16 v29, v84, v16, 0
    v_dot2_f32_bf16 v29, v85, v17, v29
    v_dot2_f32_bf16 v29, v86, v18, v29
    v_dot2_f32_bf16 v29, v87, v19, v29
    buffer_load_dwordx4 v[84:87], v46, s[36:39], 0 offen offset:1024 nt
    s_waitcnt vmcnt(16)
    v_dot2_f32_bf16 v30, v88, v16, 0
    v_dot2_f32_bf16 v30, v89, v17, v30
    v_dot2_f32_bf16 v30, v90, v18, v30
    v_dot2_f32_bf16 v30, v91, v19, v30
    buffer_load_dwordx4 v[88:91], v46, s[36:39], 0 offen offset:2048 nt
    s_waitcnt vmcnt(16)
    v_dot2_f32_bf16 v31, v92, v16, 0
    v_dot2_f32_bf16 v31, v93, v17, v31
    v_dot2_f32_bf16 v31, v94, v18, v31
    v_dot2_f32_bf16 v31, v95, v19, v31
    buffer_load_dwordx4 v[92:95], v46, s[36:39], 0 offen offset:3072 nt
    s_waitcnt vmcnt(16)
    v_dot2_f32_bf16 v32, v96, v16, 0
    v_dot2_f32_bf16 v32, v97, v17, v32
    v_dot2_f32_bf16 v32, v98, v18, v32
    v_dot2_f32_bf16 v32, v99, v19, v32
    buffer_load_dwordx4 v[96:99], v47, s[36:39], 0 offen offset:0 nt
    s_waitcnt vmcnt(16)
    v_dot2_f32_bf16 v33, v100, v16, 0
    v_dot2_f32_bf16 v33, v101, v17, v33
    v_dot2_f32_bf16 v33, v102, v18, v33
    v_dot2_f32_bf16 v33, v103, v19, v33
    buffer_load_dwordx4 v[100:103], v47, s[36:39], 0 offen offset:1024 nt
    s_waitcnt vmcnt(16)
    v_dot2_f32_bf16 v34, v104, v16, 0
    v_dot2_f32_bf16 v34, v105, v17, v34
    v_dot2_f32_bf16 v34, v106, v18, v34
    v_dot2_f32_bf16 v34, v107, v19, v34
    buffer_load_dwordx4 v[104:107], v47, s[36:39], 0 offen offset:2048 nt
    s_waitcnt vmcnt(16)
    v_dot2_f32_bf16 v35, v108, v16, 0
    v_dot2_f32_bf16 v35, v109, v17, v35
    v_dot2_f32_bf16 v35, v110, v18, v35
    v_dot2_f32_bf16 v35, v111, v19, v35
    buffer_load_dwordx4 v[108:111], v47, s[36:39], 0 offen offset:3072 nt
    v_add_f32_dpp v20, v20, v20 row_ror:8 row_mask:0xf bank_mask:0x3
    v_add_f32_dpp v20, v28, v28 row_ror:8 row_mask:0xf bank_mask:0xc
    v_add_f32_dpp v21, v21, v21 row_ror:8 row_mask:0xf bank_mask:0x3
    v_add_f32_dpp v21, v29, v29 row_ror:8 row_mask:0xf bank_mask:0xc
    v_add_f32_dpp v22, v22, v22 row_ror:8 row_mask:0xf bank_mask:0x3
    v_add_f32_dpp v22, v30, v30 row_ror:8 row_mask:0xf bank_mask:0xc
    v_add_f32_dpp v23, v23, v23 row_ror:8 row_mask:0xf bank_mask:0x3
    v_add_f32_dpp v23, v31, v31 row_ror:8 row_mask:0xf bank_mask:0xc
    v_add_f32_dpp v24, v24, v24 row_ror:8 row_mask:0xf bank_mask:0x3
    v_add_f32_dpp v24, v32, v32 row_ror:8 row_mask:0xf bank_mask:0xc
    v_add_f32_dpp v25, v25, v25 row_ror:8 row_mask:0xf bank_mask:0x3
    v_add_f32_dpp v25, v33, v33 row_ror:8 row_mask:0xf bank_mask:0xc
    v_add_f32_dpp v26, v26, v26 row_ror:8 row_mask:0xf bank_mask:0x3
    v_add_f32_dpp v26, v34, v34 row_ror:8 row_mask:0xf bank_mask:0xc
    v_add_f32_dpp v27, v27, v27 row_ror:8 row_mask:0xf bank_mask:0x3
    v_add_f32_dpp v27, v35, v35 row_ror:8 row_mask:0xf bank_mask:0xc
    v_add_f32_dpp v20, v20, v20 row_half_mirror row_mask:0xf bank_mask:0x5
    v_add_f32_dpp v20, v24, v24 row_half_mirror row_mask:0xf bank_mask:0xa
    v_add_f32_dpp v21, v21, v21 row_half_mirror row_mask:0xf bank_mask:0x5
    v_add_f32_dpp v21, v25, v25 row_half_mirror row_mask:0xf bank_mask:0xa
    v_add_f32_dpp v22, v22, v22 row_half_mirror row_mask:0xf bank_mask:0x5
    v_add_f32_dpp v22, v26, v26 row_half_mirror row_mask:0xf bank_mask:0xa
    v_add_f32_dpp v23, v23, v23 row_half_mirror row_mask:0xf bank_mask:0x5
    v_add_f32_dpp v23, v27, v27 row_half_mirror row_mask:0xf bank_mask:0xa
    v_add_f32_dpp v36, v20, v20 quad_perm:[3,2,1,0] row_mask:0xf bank_mask:0xf
    v_add_f32_dpp v37, v22, v22 quad_perm:[3,2,1,0] row_mask:0xf bank_mask:0xf
    v_add_f32_dpp v38, v21, v21 quad_perm:[3,2,1,0] row_mask:0xf bank_mask:0xf
    v_add_f32_dpp v39, v23, v23 quad_perm:[3,2,1,0] row_mask:0xf bank_mask:0xf
    v_cndmask_b32 v20, v36, v37, s[48:49]
    v_cndmask_b32 v21, v38, v39, s[48:49]
    s_nop 1
    v_add_f32_dpp v36, v20, v20 quad_perm:[1,0,3,2] row_mask:0xf bank_mask:0xf
    v_add_f32_dpp v37, v21, v21 quad_perm:[1,0,3,2] row_mask:0xf bank_mask:0xf
    v_cndmask_b32 v20, v36, v37, s[50:51]
    v_cvt_pk_bf16_f32 v20, v20, v20
    v_and_b32 v20, s43, v20
    v_mul_f32 v20, 0x3db504f3, v20
    v_cvt_pk_bf16_f32 v20, v20, v20
    v_and_b32 v20, s43, v20
    v_max_f32 v21, v20, v6
    s_nop 1
    v_max_f32_dpp v21, v21, v21 row_ror:8 row_mask:0xf bank_mask:0xf
    s_nop 1
    v_max_f32_dpp v21, v21, v21 row_half_mirror row_mask:0xf bank_mask:0xf
    s_nop 1
    v_max_f32_dpp v21, v21, v21 quad_perm:[3,2,1,0] row_mask:0xf bank_mask:0xf
    s_nop 1
    v_max_f32_dpp v21, v21, v21 quad_perm:[1,0,3,2] row_mask:0xf bank_mask:0xf
    v_sub_f32 v22, v6, v21
    v_sub_f32 v23, v20, v21
    v_mul_f32 v22, 0x3fb8aa3b, v22
    v_mul_f32 v23, 0x3fb8aa3b, v23
    v_exp_f32 v22, v22
    v_exp_f32 v23, v23
    v_mov_b32 v6, v21
    v_cvt_pk_bf16_f32 v25, v4, v23
    v_cvt_pk_bf16_f32 v24, v23, v4
    v_fma_f32 v7, v7, v22, v25
    v_mul_f32 v8, v8, v22
    v_mul_f32 v9, v9, v22
    v_mul_f32 v10, v10, v22
    v_mul_f32 v11, v11, v22
    v_mul_f32 v12, v12, v22
    v_mul_f32 v13, v13, v22
    v_mul_f32 v14, v14, v22
    v_mul_f32 v15, v15, v22
    s_waitcnt vmcnt(15)
    v_readfirstlane_b32 s46, v3
    s_add_u32 s46, s46, 96
    s_lshl_b32 s47, s46, 12
    s_cmp_lt_u32 s46, 512
    s_cselect_b32 s34, 0x200000, 0
    v_add_u32 v44, s47, v1
    v_add_u32 v45, 4096, v44
    v_add_u32 v46, 8192, v44
    v_add_u32 v47, 12288, v44
    s_waitcnt vmcnt(15)
    v_dot2c_f32_bf16_dpp v8, v24, v48 row_newbcast:0 row_mask:0xf bank_mask:0xf
    v_dot2c_f32_bf16_dpp v9, v25, v48 row_newbcast:0 row_mask:0xf bank_mask:0xf
    v_dot2c_f32_bf16_dpp v10, v24, v49 row_newbcast:0 row_mask:0xf bank_mask:0xf
    v_dot2c_f32_bf16_dpp v11, v25, v49 row_newbcast:0 row_mask:0xf bank_mask:0xf
    v_dot2c_f32_bf16_dpp v12, v24, v50 row_newbcast:0 row_mask:0xf bank_mask:0xf
    v_dot2c_f32_bf16_dpp v13, v25, v50 row_newbcast:0 row_mask:0xf bank_mask:0xf
    v_dot2c_f32_bf16_dpp v14, v24, v51 row_newbcast:0 row_mask:0xf bank_mask:0xf
    v_dot2c_f32_bf16_dpp v15, v25, v51 row_newbcast:0 row_mask:0xf bank_mask:0xf
    buffer_load_dwordx4 v[48:51], v44, s[32:35], 0 offen offset:0 nt
    s_waitcnt vmcnt(15)
    v_dot2c_f32_bf16_dpp v8, v24, v52 row_newbcast:1 row_mask:0xf bank_mask:0xf
    v_dot2c_f32_bf16_dpp v9, v25, v52 row_newbcast:1 row_mask:0xf bank_mask:0xf
    v_dot2c_f32_bf16_dpp v10, v24, v53 row_newbcast:1 row_mask:0xf bank_mask:0xf
    v_dot2c_f32_bf16_dpp v11, v25, v53 row_newbcast:1 row_mask:0xf bank_mask:0xf
    v_dot2c_f32_bf16_dpp v12, v24, v54 row_newbcast:1 row_mask:0xf bank_mask:0xf
    v_dot2c_f32_bf16_dpp v13, v25, v54 row_newbcast:1 row_mask:0xf bank_mask:0xf
    v_dot2c_f32_bf16_dpp v14, v24, v55 row_newbcast:1 row_mask:0xf bank_mask:0xf
    v_dot2c_f32_bf16_dpp v15, v25, v55 row_newbcast:1 row_mask:0xf bank_mask:0xf
    buffer_load_dwordx4 v[52:55], v44, s[32:35], 0 offen offset:1024 nt
    s_waitcnt vmcnt(15)
    v_dot2c_f32_bf16_dpp v8, v24, v56 row_newbcast:2 row_mask:0xf bank_mask:0xf
    v_dot2c_f32_bf16_dpp v9, v25, v56 row_newbcast:2 row_mask:0xf bank_mask:0xf
    v_dot2c_f32_bf16_dpp v10, v24, v57 row_newbcast:2 row_mask:0xf bank_mask:0xf
    v_dot2c_f32_bf16_dpp v11, v25, v57 row_newbcast:2 row_mask:0xf bank_mask:0xf
    v_dot2c_f32_bf16_dpp v12, v24, v58 row_newbcast:2 row_mask:0xf bank_mask:0xf
    v_dot2c_f32_bf16_dpp v13, v25, v58 row_newbcast:2 row_mask:0xf bank_mask:0xf
    v_dot2c_f32_bf16_dpp v14, v24, v59 row_newbcast:2 row_mask:0xf bank_mask:0xf
    v_dot2c_f32_bf16_dpp v15, v25, v59 row_newbcast:2 row_mask:0xf bank_mask:0xf
    buffer_load_dwordx4 v[56:59], v44, s[32:35], 0 offen offset:2048 nt
    s_waitcnt vmcnt(15)
    v_dot2c_f32_bf16_dpp v8, v24, v60 row_newbcast:3 row_mask:0xf bank_mask:0xf
    v_dot2c_f32_bf16_dpp v9, v25, v60 row_newbcast:3 row_mask:0xf bank_mask:0xf
    v_dot2c_f32_bf16_dpp v10, v24, v61 row_newbcast:3 row_mask:0xf bank_mask:0xf
    v_dot2c_f32_bf16_dpp v11, v25, v61 row_newbcast:3 row_mask:0xf bank_mask:0xf
    v_dot2c_f32_bf16_dpp v12, v24, v62 row_newbcast:3 row_mask:0xf bank_mask:0xf
    v_dot2c_f32_bf16_dpp v13, v25, v62 row_newbcast:3 row_mask:0xf bank_mask:0xf
    v_dot2c_f32_bf16_dpp v14, v24, v63 row_newbcast:3 row_mask:0xf bank_mask:0xf
    v_dot2c_f32_bf16_dpp v15, v25, v63 row_newbcast:3 row_mask:0xf bank_mask:0xf
    buffer_load_dwordx4 v[60:63], v44, s[32:35], 0 offen offset:3072 nt
    s_waitcnt vmcnt(15)
    v_dot2c_f32_bf16_dpp v8, v24, v64 row_newbcast:4 row_mask:0xf bank_mask:0xf
    v_dot2c_f32_bf16_dpp v9, v25, v64 row_newbcast:4 row_mask:0xf bank_mask:0xf
    v_dot2c_f32_bf16_dpp v10, v24, v65 row_newbcast:4 row_mask:0xf bank_mask:0xf
    v_dot2c_f32_bf16_dpp v11, v25, v65 row_newbcast:4 row_mask:0xf bank_mask:0xf
    v_dot2c_f32_bf16_dpp v12, v24, v66 row_newbcast:4 row_mask:0xf bank_mask:0xf
    v_dot2c_f32_bf16_dpp v13, v25, v66 row_newbcast:4 row_mask:0xf bank_mask:0xf
    v_dot2c_f32_bf16_dpp v14, v24, v67 row_newbcast:4 row_mask:0xf bank_mask:0xf
    v_dot2c_f32_bf16_dpp v15, v25, v67 row_newbcast:4 row_mask:0xf bank_mask:0xf
    buffer_load_dwordx4 v[64:67], v45, s[32:35], 0 offen offset:0 nt
    s_waitcnt vmcnt(15)
    v_dot2c_f32_bf16_dpp v8, v24, v68 row_newbcast:5 row_mask:0xf bank_mask:0xf
    v_dot2c_f32_bf16_dpp v9, v25, v68 row_newbcast:5 row_mask:0xf bank_mask:0xf
    v_dot2c_f32_bf16_dpp v10, v24, v69 row_newbcast:5 row_mask:0xf bank_mask:0xf
    v_dot2c_f32_bf16_dpp v11, v25, v69 row_newbcast:5 row_mask:0xf bank_mask:0xf
    v_dot2c_f32_bf16_dpp v12, v24, v70 row_newbcast:5 row_mask:0xf bank_mask:0xf
    v_dot2c_f32_bf16_dpp v13, v25, v70 row_newbcast:5 row_mask:0xf bank_mask:0xf
    v_dot2c_f32_bf16_dpp v14, v24, v71 row_newbcast:5 row_mask:0xf bank_mask:0xf
    v_dot2c_f32_bf16_dpp v15, v25, v71 row_newbcast:5 row_mask:0xf bank_mask:0xf
    buffer_load_dwordx4 v[68:71], v45, s[32:35], 0 offen offset:1024 nt
    s_waitcnt vmcnt(15)
    v_dot2c_f32_bf16_dpp v8, v24, v72 row_newbcast:6 row_mask:0xf bank_mask:0xf
    v_dot2c_f32_bf16_dpp v9, v25, v72 row_newbcast:6 row_mask:0xf bank_mask:0xf
    v_dot2c_f32_bf16_dpp v10, v24, v73 row_newbcast:6 row_mask:0xf bank_mask:0xf
    v_dot2c_f32_bf16_dpp v11, v25, v73 row_newbcast:6 row_mask:0xf bank_mask:0xf
    v_dot2c_f32_bf16_dpp v12, v24, v74 row_newbcast:6 row_mask:0xf bank_mask:0xf
    v_dot2c_f32_bf16_dpp v13, v25, v74 row_newbcast:6 row_mask:0xf bank_mask:0xf
    v_dot2c_f32_bf16_dpp v14, v24, v75 row_newbcast:6 row_mask:0xf bank_mask:0xf
    v_dot2c_f32_bf16_dpp v15, v25, v75 row_newbcast:6 row_mask:0xf bank_mask:0xf
    buffer_load_dwordx4 v[72:75], v45, s[32:35], 0 offen offset:2048 nt
    s_waitcnt vmcnt(15)
    v_dot2c_f32_bf16_dpp v8, v24, v76 row_newbcast:7 row_mask:0xf bank_mask:0xf
    v_dot2c_f32_bf16_dpp v9, v25, v76 row_newbcast:7 row_mask:0xf bank_mask:0xf
    v_dot2c_f32_bf16_dpp v10, v24, v77 row_newbcast:7 row_mask:0xf bank_mask:0xf
    v_dot2c_f32_bf16_dpp v11, v25, v77 row_newbcast:7 row_mask:0xf bank_mask:0xf
    v_dot2c_f32_bf16_dpp v12, v24, v78 row_newbcast:7 row_mask:0xf bank_mask:0xf
    v_dot2c_f32_bf16_dpp v13, v25, v78 row_newbcast:7 row_mask:0xf bank_mask:0xf
    v_dot2c_f32_bf16_dpp v14, v24, v79 row_newbcast:7 row_mask:0xf bank_mask:0xf
    v_dot2c_f32_bf16_dpp v15, v25, v79 row_newbcast:7 row_mask:0xf bank_mask:0xf
    buffer_load_dwordx4 v[76:79], v45, s[32:35], 0 offen offset:3072 nt
    s_waitcnt vmcnt(15)
    v_dot2c_f32_bf16_dpp v8, v24, v80 row_newbcast:8 row_mask:0xf bank_mask:0xf
    v_dot2c_f32_bf16_dpp v9, v25, v80 row_newbcast:8 row_mask:0xf bank_mask:0xf
    v_dot2c_f32_bf16_dpp v10, v24, v81 row_newbcast:8 row_mask:0xf bank_mask:0xf
    v_dot2c_f32_bf16_dpp v11, v25, v81 row_newbcast:8 row_mask:0xf bank_mask:0xf
    v_dot2c_f32_bf16_dpp v12, v24, v82 row_newbcast:8 row_mask:0xf bank_mask:0xf
    v_dot2c_f32_bf16_dpp v13, v25, v82 row_newbcast:8 row_mask:0xf bank_mask:0xf
    v_dot2c_f32_bf16_dpp v14, v24, v83 row_newbcast:8 row_mask:0xf bank_mask:0xf
    v_dot2c_f32_bf16_dpp v15, v25, v83 row_newbcast:8 row_mask:0xf bank_mask:0xf
    buffer_load_dwordx4 v[80:83], v46, s[32:35], 0 offen offset:0 nt
    s_waitcnt vmcnt(15)
    v_dot2c_f32_bf16_dpp v8, v24, v84 row_newbcast:9 row_mask:0xf bank_mask:0xf
    v_dot2c_f32_bf16_dpp v9, v25, v84 row_newbcast:9 row_mask:0xf bank_mask:0xf
    v_dot2c_f32_bf16_dpp v10, v24, v85 row_newbcast:9 row_mask:0xf bank_mask:0xf
    v_dot2c_f32_bf16_dpp v11, v25, v85 row_newbcast:9 row_mask:0xf bank_mask:0xf
    v_dot2c_f32_bf16_dpp v12, v24, v86 row_newbcast:9 row_mask:0xf bank_mask:0xf
    v_dot2c_f32_bf16_dpp v13, v25, v86 row_newbcast:9 row_mask:0xf bank_mask:0xf
    v_dot2c_f32_bf16_dpp v14, v24, v87 row_newbcast:9 row_mask:0xf bank_mask:0xf
    v_dot2c_f32_bf16_dpp v15, v25, v87 row_newbcast:9 row_mask:0xf bank_mask:0xf
    buffer_load_dwordx4 v[84:87], v46, s[32:35], 0 offen offset:1024 nt
    s_waitcnt vmcnt(15)
    v_dot2c_f32_bf16_dpp v8, v24, v88 row_newbcast:10 row_mask:0xf bank_mask:0xf
    v_dot2c_f32_bf16_dpp v9, v25, v88 row_newbcast:10 row_mask:0xf bank_mask:0xf
    v_dot2c_f32_bf16_dpp v10, v24, v89 row_newbcast:10 row_mask:0xf bank_mask:0xf
    v_dot2c_f32_bf16_dpp v11, v25, v89 row_newbcast:10 row_mask:0xf bank_mask:0xf
    v_dot2c_f32_bf16_dpp v12, v24, v90 row_newbcast:10 row_mask:0xf bank_mask:0xf
    v_dot2c_f32_bf16_dpp v13, v25, v90 row_newbcast:10 row_mask:0xf bank_mask:0xf
    v_dot2c_f32_bf16_dpp v14, v24, v91 row_newbcast:10 row_mask:0xf bank_mask:0xf
    v_dot2c_f32_bf16_dpp v15, v25, v91 row_newbcast:10 row_mask:0xf bank_mask:0xf
    buffer_load_dwordx4 v[88:91], v46, s[32:35], 0 offen offset:2048 nt
    s_waitcnt vmcnt(15)
    v_dot2c_f32_bf16_dpp v8, v24, v92 row_newbcast:11 row_mask:0xf bank_mask:0xf
    v_dot2c_f32_bf16_dpp v9, v25, v92 row_newbcast:11 row_mask:0xf bank_mask:0xf
    v_dot2c_f32_bf16_dpp v10, v24, v93 row_newbcast:11 row_mask:0xf bank_mask:0xf
    v_dot2c_f32_bf16_dpp v11, v25, v93 row_newbcast:11 row_mask:0xf bank_mask:0xf
    v_dot2c_f32_bf16_dpp v12, v24, v94 row_newbcast:11 row_mask:0xf bank_mask:0xf
    v_dot2c_f32_bf16_dpp v13, v25, v94 row_newbcast:11 row_mask:0xf bank_mask:0xf
    v_dot2c_f32_bf16_dpp v14, v24, v95 row_newbcast:11 row_mask:0xf bank_mask:0xf
    v_dot2c_f32_bf16_dpp v15, v25, v95 row_newbcast:11 row_mask:0xf bank_mask:0xf
    buffer_load_dwordx4 v[92:95], v46, s[32:35], 0 offen offset:3072 nt
    s_waitcnt vmcnt(15)
    v_dot2c_f32_bf16_dpp v8, v24, v96 row_newbcast:12 row_mask:0xf bank_mask:0xf
    v_dot2c_f32_bf16_dpp v9, v25, v96 row_newbcast:12 row_mask:0xf bank_mask:0xf
    v_dot2c_f32_bf16_dpp v10, v24, v97 row_newbcast:12 row_mask:0xf bank_mask:0xf
    v_dot2c_f32_bf16_dpp v11, v25, v97 row_newbcast:12 row_mask:0xf bank_mask:0xf
    v_dot2c_f32_bf16_dpp v12, v24, v98 row_newbcast:12 row_mask:0xf bank_mask:0xf
    v_dot2c_f32_bf16_dpp v13, v25, v98 row_newbcast:12 row_mask:0xf bank_mask:0xf
    v_dot2c_f32_bf16_dpp v14, v24, v99 row_newbcast:12 row_mask:0xf bank_mask:0xf
    v_dot2c_f32_bf16_dpp v15, v25, v99 row_newbcast:12 row_mask:0xf bank_mask:0xf
    buffer_load_dwordx4 v[96:99], v47, s[32:35], 0 offen offset:0 nt
    s_waitcnt vmcnt(15)
    v_dot2c_f32_bf16_dpp v8, v24, v100 row_newbcast:13 row_mask:0xf bank_mask:0xf
    v_dot2c_f32_bf16_dpp v9, v25, v100 row_newbcast:13 row_mask:0xf bank_mask:0xf
    v_dot2c_f32_bf16_dpp v10, v24, v101 row_newbcast:13 row_mask:0xf bank_mask:0xf
    v_dot2c_f32_bf16_dpp v11, v25, v101 row_newbcast:13 row_mask:0xf bank_mask:0xf
    v_dot2c_f32_bf16_dpp v12, v24, v102 row_newbcast:13 row_mask:0xf bank_mask:0xf
    v_dot2c_f32_bf16_dpp v13, v25, v102 row_newbcast:13 row_mask:0xf bank_mask:0xf
    v_dot2c_f32_bf16_dpp v14, v24, v103 row_newbcast:13 row_mask:0xf bank_mask:0xf
    v_dot2c_f32_bf16_dpp v15, v25, v103 row_newbcast:13 row_mask:0xf bank_mask:0xf
    buffer_load_dwordx4 v[100:103], v47, s[32:35], 0 offen offset:1024 nt
    s_waitcnt vmcnt(15)
    v_dot2c_f32_bf16_dpp v8, v24, v104 row_newbcast:14 row_mask:0xf bank_mask:0xf
    v_dot2c_f32_bf16_dpp v9, v25, v104 row_newbcast:14 row_mask:0xf bank_mask:0xf
    v_dot2c_f32_bf16_dpp v10, v24, v105 row_newbcast:14 row_mask:0xf bank_mask:0xf
    v_dot2c_f32_bf16_dpp v11, v25, v105 row_newbcast:14 row_mask:0xf bank_mask:0xf
    v_dot2c_f32_bf16_dpp v12, v24, v106 row_newbcast:14 row_mask:0xf bank_mask:0xf
    v_dot2c_f32_bf16_dpp v13, v25, v106 row_newbcast:14 row_mask:0xf bank_mask:0xf
    v_dot2c_f32_bf16_dpp v14, v24, v107 row_newbcast:14 row_mask:0xf bank_mask:0xf
    v_dot2c_f32_bf16_dpp v15, v25, v107 row_newbcast:14 row_mask:0xf bank_mask:0xf
    buffer_load_dwordx4 v[104:107], v47, s[32:35], 0 offen offset:2048 nt
    s_waitcnt vmcnt(15)
    v_dot2c_f32_bf16_dpp v8, v24, v108 row_newbcast:15 row_mask:0xf bank_mask:0xf
    v_dot2c_f32_bf16_dpp v9, v25, v108 row_newbcast:15 row_mask:0xf bank_mask:0xf
    v_dot2c_f32_bf16_dpp v10, v24, v109 row_newbcast:15 row_mask:0xf bank_mask:0xf
    v_dot2c_f32_bf16_dpp v11, v25, v109 row_newbcast:15 row_mask:0xf bank_mask:0xf
    v_dot2c_f32_bf16_dpp v12, v24, v110 row_newbcast:15 row_mask:0xf bank_mask:0xf
    v_dot2c_f32_bf16_dpp v13, v25, v110 row_newbcast:15 row_mask:0xf bank_mask:0xf
    v_dot2c_f32_bf16_dpp v14, v24, v111 row_newbcast:15 row_mask:0xf bank_mask:0xf
    v_dot2c_f32_bf16_dpp v15, v25, v111 row_newbcast:15 row_mask:0xf bank_mask:0xf
    buffer_load_dwordx4 v[108:111], v47, s[32:35], 0 offen offset:3072 nt
    s_cmp_lt_u32 s46, 512
    s_cbranch_scc1 L_loop
L_done:
    v_lshlrev_b32 v45, 1, v1
    s_lshl_b32 s54, s3, 11
    v_add_u32 v45, s54, v45
    ds_write_b128 v45, v[8:11] offset:20480
    ds_write_b128 v45, v[12:15] offset:20496
    s_nop 1
    v_add_f32_dpp v7, v7, v7 row_ror:8 row_mask:0xf bank_mask:0xf
    s_nop 1
    v_add_f32_dpp v7, v7, v7 row_half_mirror row_mask:0xf bank_mask:0xf
    s_nop 1
    v_add_f32_dpp v7, v7, v7 quad_perm:[3,2,1,0] row_mask:0xf bank_mask:0xf
    s_nop 1
    v_add_f32_dpp v7, v7, v7 quad_perm:[1,0,3,2] row_mask:0xf bank_mask:0xf
    v_lshrrev_b32 v46, 8, v1
    v_lshlrev_b32 v46, 3, v46
    s_lshl_b32 s54, s3, 5
    v_add_u32 v46, s54, v46
    s_mov_b32 exec_lo, 0x00010001
    s_mov_b32 exec_hi, 0x00010001
    ds_write_b64 v46, v[6:7] offset:28672
    s_mov_b64 exec, -1
    s_waitcnt lgkmcnt(0)
    s_barrier
    s_endpgm
L_aux:
    s_sub_u32 s34, s3, 4
    v_and_b32 v2, 15, v1
    v_lshrrev_b32 v3, 4, v1
    v_lshlrev_b32 v11, 4, v2
    s_mul_i32 s52, s34, 1280
    s_mul_i32 s53, s31, 160
    s_add_u32 s53, s53, s52
    v_cmp_gt_u32 vcc, 40, v1
    v_lshlrev_b32 v9, 5, v1
    v_add_u32 v9, s52, v9
    v_lshlrev_b32 v15, 2, v1
    v_add_u32 v15, s53, v15
    v_mov_b32 v13, 0x7f000000
    v_cndmask_b32 v9, v13, v9, vcc
    v_cndmask_b32 v15, v13, v15, vcc
    v_lshlrev_b32 v10, 13, v3
    v_add_u32 v10, v10, v11
    s_mul_i32 s35, s31, 80
    s_mul_i32 s52, s34, 20
    s_add_u32 s35, s35, s52
    s_lshl_b32 s52, s35, 13
    s_lshl_b32 s53, s30, 8
    s_add_u32 s52, s52, s53
    s_mov_b32 s42, 5120
    s_mov_b32 s43, 0x20000
    s_mov_b32 s46, 5242880
    s_mov_b32 s47, 0x20000
    s_waitcnt lgkmcnt(0)
    s_mov_b32 s40, s4
    s_mov_b32 s41, s5
    buffer_load_dwordx4 v[16:19], v9, s[40:43], 0 offen
    buffer_load_dwordx4 v[20:23], v9, s[40:43], 0 offen offset:16
    buffer_load_dword v24, v15, s[40:43], 0 offen
    s_mov_b32 s44, s10
    s_mov_b32 s45, s11
    buffer_load_dwordx4 v[36:39], v10, s[44:47], s52 offen nt
    s_add_u32 s52, s52, 32768
    buffer_load_dwordx4 v[40:43], v10, s[44:47], s52 offen nt
    s_add_u32 s52, s52, 32768
    buffer_load_dwordx4 v[44:47], v10, s[44:47], s52 offen nt
    s_add_u32 s52, s52, 32768
    buffer_load_dwordx4 v[48:51], v10, s[44:47], s52 offen nt
    s_add_u32 s52, s52, 32768
    buffer_load_dwordx4 v[52:55], v10, s[44:47], s52 offen nt
    s_load_dword s96, s[28:29], 983040
    s_mov_b32 s36, s28
    s_mov_b32 s37, s29
    s_mov_b32 s38, 16777216
    s_mov_b32 s39, 0x20000
    s_lshl_b32 s54, s32, 6
    s_add_u32 s54, s54, s30
    s_lshl_b32 s54, s54, 8
    s_cmp_lg_u32 s33, 0
    s_cselect_b32 s54, 0x7f000000, s54
    s_cmp_lg_u32 s34, 2
    s_cselect_b32 s54, 0x7f000000, s54
    v_lshlrev_b32 v171, 13, v1
    v_cmp_gt_u32 vcc, 2, v1
    v_mov_b32 v172, 0x7f000000
    v_add_u32 v171, s54, v171
    v_cndmask_b32 v171, v172, v171, vcc
    v_mov_b32 v172, 0
    buffer_store_dword v172, v171, s[36:39], 0 offen sc1
    s_barrier
    v_lshlrev_b32 v8, 4, v1
    s_mov_b32 s95, 15
    s_mov_b32 s97, 255
    s_mov_b32 s98, 255
    s_mov_b32 s99, 0
    s_mov_b32 s62, 255
    s_sub_u32 s52, s31, 1
    s_cmp_lt_u32 s31, 3
    s_cselect_b32 s97, s31, s97
    s_cmp_eq_u32 s31, 4
    s_cselect_b32 s97, s52, s97
    s_cmp_eq_u32 s31, 5
    s_cselect_b32 s97, s52, s97
    s_mul_i32 s52, s30, 3
    s_cmp_eq_u32 s31, 3
    s_cselect_b32 s98, 0, s98
    s_cselect_b32 s99, 2, s99
    s_cselect_b32 s62, s52, s62
    s_add_u32 s52, s52, 1
    s_cmp_eq_u32 s31, 6
    s_cselect_b32 s98, 2, s98
    s_cselect_b32 s99, 2, s99
    s_cselect_b32 s62, s52, s62
    s_add_u32 s52, s52, 1
    s_cmp_eq_u32 s31, 7
    s_cselect_b32 s98, 4, s98
    s_cselect_b32 s99, 1, s99
    s_cselect_b32 s62, s52, s62
    s_lshl_b32 s52, s30, 2
    s_lshl_b32 s53, s32, 1
    s_add_u32 s52, s52, s53
    s_lshl_b32 s52, s52, 2
    s_add_u32 s52, s52, s33
    s_lshl_b32 s52, s52, 10
    s_add_u32 s57, s52, 3145728
    s_mul_i32 s56, s30, 5
    v_and_b32 v100, 7, v1
    v_lshrrev_b32 v101, 1, v100
    v_and_b32 v100, 1, v100
    v_lshlrev_b32 v100, 4, v100
    v_mov_b32 v102, 0xffff
    v_lshlrev_b32 v102, v100, v102
    v_cmp_eq_u32 vcc, 0, v101
    s_nop 1
    v_cndmask_b32 v104, 0, v102, vcc
    v_cmp_eq_u32 vcc, 1, v101
    s_nop 1
    v_cndmask_b32 v105, 0, v102, vcc
    v_cmp_eq_u32 vcc, 2, v101
    s_nop 1
    v_cndmask_b32 v106, 0, v102, vcc
    v_cmp_eq_u32 vcc, 3, v101
    s_nop 1
    v_cndmask_b32 v107, 0, v102, vcc
    v_lshrrev_b32 v12, 3, v1
    v_and_b32 v12, 1, v12
    v_mul_u32_u24 v102, 320, v12
    s_mul_i32 s52, s34, 20
    v_add_u32 v79, s52, v3
    v_lshlrev_b32 v79, 2, v79
    v_add_u32 v102, v102, v79
    s_mul_i32 s52, s34, 320
    v_lshlrev_b32 v79, 3, v1
    v_add_u32 v79, s52, v79
    v_mov_b32 v90, 0x3f803f80
    v_mov_b32 v91, 0
    v_mov_b32 v92, 0
    v_mov_b32 v93, 0
    v_mov_b32 v94, 0
    v_lshrrev_b32 v100, 1, v3
    v_lshlrev_b32 v100, 9, v100
    v_lshlrev_b32 v101, 5, v2
    v_add_u32 v100, v100, v101
    v_and_b32 v101, 1, v3
    v_lshlrev_b32 v101, 4, v101
    v_add_u32 v103, v100, v101
    v_mul_u32_u24 v14, 1280, v3
    v_add_u32 v14, v14, v11
    v_and_b32 v109, 31, v1
    v_lshlrev_b32 v13, 4, v109
    s_waitcnt vmcnt(6)
    v_dot2c_f32_bf16 v91, v16, v90
    v_dot2c_f32_bf16 v92, v16, v16
    v_dot2c_f32_bf16 v93, v17, v90
    v_dot2c_f32_bf16 v94, v17, v17
    v_dot2c_f32_bf16 v91, v18, v90
    v_dot2c_f32_bf16 v92, v18, v18
    v_dot2c_f32_bf16 v93, v19, v90
    v_dot2c_f32_bf16 v94, v19, v19
    v_dot2c_f32_bf16 v91, v20, v90
    v_dot2c_f32_bf16 v92, v20, v20
    v_dot2c_f32_bf16 v93, v21, v90
    v_dot2c_f32_bf16 v94, v21, v21
    v_dot2c_f32_bf16 v91, v22, v90
    v_dot2c_f32_bf16 v92, v22, v22
    v_dot2c_f32_bf16 v93, v23, v90
    v_dot2c_f32_bf16 v94, v23, v23
    v_lshlrev_b32 v95, 16, v24
    v_and_b32 v96, 0xffff0000, v24
    s_nop 0
    v_add_f32 v91, v91, v93
    v_add_f32 v92, v92, v94
    s_nop 1
    v_add_f32_dpp v91, v91, v91 row_ror:8 row_mask:0xf bank_mask:0xf
    v_add_f32_dpp v92, v92, v92 row_ror:8 row_mask:0xf bank_mask:0xf
    s_nop 1
    v_add_f32_dpp v91, v91, v91 row_half_mirror row_mask:0xf bank_mask:0xf
    v_add_f32_dpp v92, v92, v92 row_half_mirror row_mask:0xf bank_mask:0xf
    s_nop 1
    v_add_f32_dpp v91, v91, v91 quad_perm:[3,2,1,0] row_mask:0xf bank_mask:0xf
    v_add_f32_dpp v92, v92, v92 quad_perm:[3,2,1,0] row_mask:0xf bank_mask:0xf
    s_nop 1
    v_add_f32_dpp v91, v91, v91 quad_perm:[1,0,3,2] row_mask:0xf bank_mask:0xf
    v_add_f32_dpp v92, v92, v92 quad_perm:[1,0,3,2] row_mask:0xf bank_mask:0xf
    v_mov_b32 v93, v91
    v_mov_b32 v94, v92
    s_nop 1
    v_permlane16_swap_b32 v91, v93
    v_permlane16_swap_b32 v92, v94
    s_nop 1
    v_add_f32 v91, v91, v93
    v_add_f32 v92, v92, v94
    v_mov_b32 v93, v91
    v_mov_b32 v94, v92
    s_nop 1
    v_permlane32_swap_b32 v91, v93
    v_permlane32_swap_b32 v92, v94
    s_nop 1
    v_add_f32 v91, v91, v93
    v_add_f32 v92, v92, v94
    v_mul_f32 v91, 0x3acccccd, v91
    v_mul_f32 v92, 0x3acccccd, v92
    v_fma_f32 v92, -v91, v91, v92
    v_max_f32 v92, 0, v92
    v_cvt_pk_bf16_f32 v91, v91, v92
    v_and_b32 v92, 0xffff0000, v91
    v_lshlrev_b32 v91, 16, v91
    v_add_f32 v92, 0x3727c5ac, v92
    v_sub_f32 v95, v95, v91
    v_sub_f32 v96, v96, v91
    v_cvt_pk_bf16_f32 v92, v92, v92
    v_and_b32 v92, 0xffff0000, v92
    v_cvt_pk_bf16_f32 v95, v95, v96
    v_sqrt_f32 v92, v92
    v_and_b32 v96, 0xffff0000, v95
    v_lshlrev_b32 v95, 16, v95
    v_cvt_pk_bf16_f32 v92, v92, v92
    v_and_b32 v92, 0xffff0000, v92
    v_rcp_f32 v93, v92
    s_nop 0
    v_mul_f32 v97, v95, v93
    v_mul_f32 v98, v96, v93
    v_fma_f32 v99, -v97, v92, v95
    v_fma_f32 v100, -v98, v92, v96
    v_fma_f32 v97, v99, v93, v97
    v_fma_f32 v98, v100, v93, v98
    v_cvt_pk_bf16_f32 v99, v98, v98
    v_cvt_pk_bf16_f32 v98, v97, v97
    s_mov_b32 exec_hi, 0xff
    ds_write_b64 v79, v[98:99] offset:0
    s_mov_b64 exec, -1
    s_waitcnt lgkmcnt(0)
    v_mov_b32 v173, 19968
    v_mov_b32 v174, 1
    s_mov_b64 exec, 1
    ds_add_u32 v173, v174
L_lw_2:
    ds_read_b32 v174, v173
    s_waitcnt lgkmcnt(0)
    v_readfirstlane_b32 s59, v174
    s_cmp_lt_u32 s59, 4
    s_cbranch_scc1 L_lw_2
    s_mov_b64 exec, -1
    s_waitcnt vmcnt(1)
    ds_read_b32 v108, v102 offset:0
    ds_read_b32 v109, v102 offset:640
    ds_read_b32 v110, v102 offset:16
    ds_read_b32 v111, v102 offset:656
    ds_read_b32 v112, v102 offset:32
    ds_read_b32 v113, v102 offset:672
    ds_read_b32 v114, v102 offset:48
    ds_read_b32 v115, v102 offset:688
    ds_read_b32 v116, v102 offset:64
    ds_read_b32 v117, v102 offset:704
    s_waitcnt lgkmcnt(9)
    v_and_b32 v118, v104, v108
    v_and_b32 v119, v105, v108
    v_and_b32 v120, v106, v108
    v_and_b32 v121, v107, v108
    s_nop 1
    v_mfma_f32_16x16x32_bf16 v[148:151], v[118:121], v[36:39], 0
    s_waitcnt lgkmcnt(8)
    v_and_b32 v122, v104, v109
    v_and_b32 v123, v105, v109
    v_and_b32 v124, v106, v109
    v_and_b32 v125, v107, v109
    s_nop 1
    v_mfma_f32_16x16x32_bf16 v[152:155], v[122:125], v[36:39], 0
    s_waitcnt lgkmcnt(7)
    v_and_b32 v118, v104, v110
    v_and_b32 v119, v105, v110
    v_and_b32 v120, v106, v110
    v_and_b32 v121, v107, v110
    s_nop 1
    v_mfma_f32_16x16x32_bf16 v[148:151], v[118:121], v[40:43], v[148:151]
    s_waitcnt lgkmcnt(6)
    v_and_b32 v122, v104, v111
    v_and_b32 v123, v105, v111
    v_and_b32 v124, v106, v111
    v_and_b32 v125, v107, v111
    s_nop 1
    v_mfma_f32_16x16x32_bf16 v[152:155], v[122:125], v[40:43], v[152:155]
    s_waitcnt lgkmcnt(5)
    v_and_b32 v118, v104, v112
    v_and_b32 v119, v105, v112
    v_and_b32 v120, v106, v112
    v_and_b32 v121, v107, v112
    s_nop 1
    v_mfma_f32_16x16x32_bf16 v[148:151], v[118:121], v[44:47], v[148:151]
    s_waitcnt lgkmcnt(4)
    v_and_b32 v122, v104, v113
    v_and_b32 v123, v105, v113
    v_and_b32 v124, v106, v113
    v_and_b32 v125, v107, v113
    s_nop 1
    v_mfma_f32_16x16x32_bf16 v[152:155], v[122:125], v[44:47], v[152:155]
    s_waitcnt lgkmcnt(3)
    v_and_b32 v118, v104, v114
    v_and_b32 v119, v105, v114
    v_and_b32 v120, v106, v114
    v_and_b32 v121, v107, v114
    s_nop 1
    v_mfma_f32_16x16x32_bf16 v[148:151], v[118:121], v[48:51], v[148:151]
    s_waitcnt lgkmcnt(2)
    v_and_b32 v122, v104, v115
    v_and_b32 v123, v105, v115
    v_and_b32 v124, v106, v115
    v_and_b32 v125, v107, v115
    s_nop 1
    v_mfma_f32_16x16x32_bf16 v[152:155], v[122:125], v[48:51], v[152:155]
    s_waitcnt lgkmcnt(1)
    v_and_b32 v118, v104, v116
    v_and_b32 v119, v105, v116
    v_and_b32 v120, v106, v116
    v_and_b32 v121, v107, v116
    s_nop 1
    v_mfma_f32_16x16x32_bf16 v[148:151], v[118:121], v[52:55], v[148:151]
    s_waitcnt lgkmcnt(0)
    v_and_b32 v122, v104, v117
    v_and_b32 v123, v105, v117
    v_and_b32 v124, v106, v117
    v_and_b32 v125, v107, v117
    s_nop 1
    v_mfma_f32_16x16x32_bf16 v[152:155], v[122:125], v[52:55], v[152:155]
    s_nop 7
    s_lshl_b32 s52, s34, 11
    v_add_u32 v100, s52, v103
    ds_write_b128 v100, v[148:151] offset:2048
    ds_write_b128 v100, v[152:155] offset:3072
    s_waitcnt vmcnt(0) lgkmcnt(0)
    s_add_u32 s96, s96, 1
    v_mov_b32 v170, s96
    v_mov_b32 v173, 19972
    v_mov_b32 v174, 1
    s_mov_b64 exec, 1
    ds_add_u32 v173, v174
L_lw_3:
    ds_read_b32 v174, v173
    s_waitcnt lgkmcnt(0)
    v_readfirstlane_b32 s59, v174
    s_cmp_lt_u32 s59, 4
    s_cbranch_scc1 L_lw_3
    s_mov_b64 exec, -1
    s_lshl_b32 s52, s34, 9
    v_add_u32 v15, s52, v13
    s_lshl_b32 s100, s2, 12
    s_add_u32 s100, s100, 1048576
    ds_read_b128 v[16:19], v15 offset:2048
    ds_read_b128 v[20:23], v15 offset:4096
    ds_read_b128 v[24:27], v15 offset:6144
    ds_read_b128 v[28:31], v15 offset:8192
    s_waitcnt lgkmcnt(0)
    v_add_f32 v16, v16, v20
    v_add_f32 v17, v17, v21
    v_add_f32 v18, v18, v22
    v_add_f32 v19, v19, v23
    v_add_f32 v24, v24, v28
    v_add_f32 v25, v25, v29
    v_add_f32 v26, v26, v30
    v_add_f32 v27, v27, v31
    v_add_f32 v16, v16, v24
    v_add_f32 v17, v17, v25
    v_add_f32 v18, v18, v26
    v_add_f32 v19, v19, v27
    v_bfi_b32 v16, s95, v170, v16
    v_bfi_b32 v17, s95, v170, v17
    v_bfi_b32 v18, s95, v170, v18
    v_bfi_b32 v19, s95, v170, v19
    s_mov_b32 exec_hi, 0
    buffer_store_dwordx4 v[16:19], v15, s[36:39], s100 offen sc1
    s_mov_b64 exec, -1
    s_cmp_ge_u32 s34, 2
    s_cbranch_scc1 L_noq_4
    s_lshl_b32 s52, s30, 15
    s_lshl_b32 s53, s32, 1
    s_add_u32 s53, s53, s34
    s_lshl_b32 s53, s53, 9
    s_add_u32 s52, s52, s53
    s_add_u32 s52, s52, 1048576
    s_sleep 16
    v_lshlrev_b32 v128, 12, v1
    v_add_u32 v128, 508, v128
    s_mov_b64 exec, 0xff
    s_mov_b32 s58, 0
L_pollql_5:
    buffer_load_dword v112, v128, s[36:39], s52 offen sc1
    s_waitcnt vmcnt(0)
    v_xor_b32 v126, v112, v170
    v_and_b32 v126, 15, v126
    v_cmp_ne_u32 vcc, 0, v126
    s_add_u32 s58, s58, 1
    s_cbranch_vccz L_pdoneql_6
    s_cmp_lt_u32 s58, 200000
    s_cbranch_scc0 L_pdoneql_6
    s_sleep 1
    s_branch L_pollql_5
L_pdoneql_6:
    s_mov_b64 exec, -1
    v_lshrrev_b32 v128, 5, v1
    v_lshlrev_b32 v128, 12, v128
    v_add_u32 v128, v128, v13
    s_mov_b32 s58, 0
L_pollq_7:
    s_mov_b32 s53, s52
    buffer_load_dwordx4 v[112:115], v128, s[36:39], s53 offen sc1
    s_add_u32 s53, s53, 8192
    buffer_load_dwordx4 v[116:119], v128, s[36:39], s53 offen sc1
    s_add_u32 s53, s53, 8192
    buffer_load_dwordx4 v[120:123], v128, s[36:39], s53 offen sc1
    s_add_u32 s53, s53, 8192
    buffer_load_dwordx4 v[124:127], v128, s[36:39], s53 offen sc1
    s_waitcnt vmcnt(0)
    v_xor_b32 v130, v112, v170
    v_xor_b32 v131, v113, v170
    v_xor_b32 v132, v114, v170
    v_or3_b32 v130, v130, v131, v132
    v_xor_b32 v131, v115, v170
    v_xor_b32 v132, v116, v170
    v_or3_b32 v130, v130, v131, v132
    v_xor_b32 v131, v117, v170
    v_xor_b32 v132, v118, v170
    v_or3_b32 v130, v130, v131, v132
    v_xor_b32 v131, v119, v170
    v_xor_b32 v132, v120, v170
    v_or3_b32 v130, v130, v131, v132
    v_xor_b32 v131, v121, v170
    v_xor_b32 v132, v122, v170
    v_or3_b32 v130, v130, v131, v132
    v_xor_b32 v131, v123, v170
    v_xor_b32 v132, v124, v170
    v_or3_b32 v130, v130, v131, v132
    v_xor_b32 v131, v125, v170
    v_xor_b32 v132, v126, v170
    v_or3_b32 v130, v130, v131, v132
    v_xor_b32 v131, v127, v170
    v_or_b32 v130, v130, v131
    v_and_b32 v130, 15, v130
    v_cmp_ne_u32 vcc, 0, v130
    s_add_u32 s58, s58, 1
    s_cbranch_vccz L_pdoneq_8
    s_cmp_lt_u32 s58, 200000
    s_cbranch_scc0 L_pdoneq_8
    s_sleep 1
    s_branch L_pollq_7
L_pdoneq_8:
    v_add_f32 v112, v112, v116
    v_add_f32 v113, v113, v117
    v_add_f32 v114, v114, v118
    v_add_f32 v115, v115, v119
    v_add_f32 v120, v120, v124
    v_add_f32 v121, v121, v125
    v_add_f32 v122, v122, v126
    v_add_f32 v123, v123, v127
    v_add_f32 v112, v112, v120
    v_add_f32 v113, v113, v121
    v_add_f32 v114, v114, v122
    v_add_f32 v115, v115, v123
    v_mov_b32 v116, v112
    v_mov_b32 v117, v113
    v_mov_b32 v118, v114
    v_mov_b32 v119, v115
    s_nop 1
    v_permlane32_swap_b32 v112, v116
    v_permlane32_swap_b32 v113, v117
    v_permlane32_swap_b32 v114, v118
    v_permlane32_swap_b32 v115, v119
    s_nop 1
    v_add_f32 v112, v112, v116
    v_add_f32 v113, v113, v117
    v_add_f32 v114, v114, v118
    v_add_f32 v115, v115, v119
    v_cvt_pk_bf16_f32 v112, v112, v113
    v_cvt_pk_bf16_f32 v113, v114, v115
    v_lshrrev_b32 v17, 1, v13
    s_lshl_b32 s52, s34, 8
    v_add_u32 v17, s52, v17
    ds_write_b64 v17, v[112:113] offset:18432
    s_waitcnt lgkmcnt(0)
L_noq_4:
    s_barrier
    s_mov_b32 s48, s16
    s_mov_b32 s49, s17
    s_mov_b32 s50, 2211840
    s_mov_b32 s51, 0x20000
    v_cmp_gt_u32 vcc, 7, v2
    v_mul_u32_u24 v78, 3456, v3
    v_add_u32 v78, v78, v11
    v_mov_b32 v79, 0x7f000000
    v_cndmask_b32 v78, v79, v78, vcc
    s_mul_i32 s54, s35, 3456
    s_mul_i32 s55, s30, 108
    s_add_u32 s54, s54, s55
    buffer_load_dwordx4 v[56:59], v78, s[48:51], s54 offen nt
    s_add_u32 s54, s54, 13824
    buffer_load_dwordx4 v[60:63], v78, s[48:51], s54 offen nt
    s_add_u32 s54, s54, 13824
    buffer_load_dwordx4 v[64:67], v78, s[48:51], s54 offen nt
    s_add_u32 s54, s54, 13824
    buffer_load_dwordx4 v[68:71], v78, s[48:51], s54 offen nt
    s_add_u32 s54, s54, 13824
    buffer_load_dwordx4 v[72:75], v78, s[48:51], s54 offen nt
    s_waitcnt vmcnt(0)
    ds_read_b32 v108, v102 offset:0
    ds_read_b32 v109, v102 offset:640
    ds_read_b32 v110, v102 offset:16
    ds_read_b32 v111, v102 offset:656
    ds_read_b32 v112, v102 offset:32
    ds_read_b32 v113, v102 offset:672
    ds_read_b32 v114, v102 offset:48
    ds_read_b32 v115, v102 offset:688
    ds_read_b32 v116, v102 offset:64
    ds_read_b32 v117, v102 offset:704
    s_waitcnt lgkmcnt(9)
    v_and_b32 v118, v104, v108
    v_and_b32 v119, v105, v108
    v_and_b32 v120, v106, v108
    v_and_b32 v121, v107, v108
    s_nop 1
    v_mfma_f32_16x16x32_bf16 v[156:159], v[118:121], v[56:59], 0
    s_waitcnt lgkmcnt(8)
    v_and_b32 v122, v104, v109
    v_and_b32 v123, v105, v109
    v_and_b32 v124, v106, v109
    v_and_b32 v125, v107, v109
    s_nop 1
    v_mfma_f32_16x16x32_bf16 v[160:163], v[122:125], v[56:59], 0
    s_waitcnt lgkmcnt(7)
    v_and_b32 v118, v104, v110
    v_and_b32 v119, v105, v110
    v_and_b32 v120, v106, v110
    v_and_b32 v121, v107, v110
    s_nop 1
    v_mfma_f32_16x16x32_bf16 v[156:159], v[118:121], v[60:63], v[156:159]
    s_waitcnt lgkmcnt(6)
    v_and_b32 v122, v104, v111
    v_and_b32 v123, v105, v111
    v_and_b32 v124, v106, v111
    v_and_b32 v125, v107, v111
    s_nop 1
    v_mfma_f32_16x16x32_bf16 v[160:163], v[122:125], v[60:63], v[160:163]
    s_waitcnt lgkmcnt(5)
    v_and_b32 v118, v104, v112
    v_and_b32 v119, v105, v112
    v_and_b32 v120, v106, v112
    v_and_b32 v121, v107, v112
    s_nop 1
    v_mfma_f32_16x16x32_bf16 v[156:159], v[118:121], v[64:67], v[156:159]
    s_waitcnt lgkmcnt(4)
    v_and_b32 v122, v104, v113
    v_and_b32 v123, v105, v113
    v_and_b32 v124, v106, v113
    v_and_b32 v125, v107, v113
    s_nop 1
    v_mfma_f32_16x16x32_bf16 v[160:163], v[122:125], v[64:67], v[160:163]
    s_waitcnt lgkmcnt(3)
    v_and_b32 v118, v104, v114
    v_and_b32 v119, v105, v114
    v_and_b32 v120, v106, v114
    v_and_b32 v121, v107, v114
    s_nop 1
    v_mfma_f32_16x16x32_bf16 v[156:159], v[118:121], v[68:71], v[156:159]
    s_waitcnt lgkmcnt(2)
    v_and_b32 v122, v104, v115
    v_and_b32 v123, v105, v115
    v_and_b32 v124, v106, v115
    v_and_b32 v125, v107, v115
    s_nop 1
    v_mfma_f32_16x16x32_bf16 v[160:163], v[122:125], v[68:71], v[160:163]
    s_waitcnt lgkmcnt(1)
    v_and_b32 v118, v104, v116
    v_and_b32 v119, v105, v116
    v_and_b32 v120, v106, v116
    v_and_b32 v121, v107, v116
    s_nop 1
    v_mfma_f32_16x16x32_bf16 v[156:159], v[118:121], v[72:75], v[156:159]
    s_waitcnt lgkmcnt(0)
    v_and_b32 v122, v104, v117
    v_and_b32 v123, v105, v117
    v_and_b32 v124, v106, v117
    v_and_b32 v125, v107, v117
    s_nop 1
    v_mfma_f32_16x16x32_bf16 v[160:163], v[122:125], v[72:75], v[160:163]
    s_nop 7
    s_lshl_b32 s52, s34, 11
    v_add_u32 v100, s52, v103
    ds_write_b128 v100, v[156:159] offset:10240
    ds_write_b128 v100, v[160:163] offset:11264
    s_waitcnt lgkmcnt(0)
    v_mov_b32 v173, 19984
    v_mov_b32 v174, 1
    s_mov_b64 exec, 1
    ds_add_u32 v173, v174
L_lw_9:
    ds_read_b32 v174, v173
    s_waitcnt lgkmcnt(0)
    v_readfirstlane_b32 s59, v174
    s_cmp_lt_u32 s59, 4
    s_cbranch_scc1 L_lw_9
    s_mov_b64 exec, -1
    ds_read_b128 v[28:31], v15 offset:10240
    ds_read_b128 v[32:35], v15 offset:12288
    ds_read_b128 v[36:39], v15 offset:14336
    ds_read_b128 v[40:43], v15 offset:16384
    s_waitcnt lgkmcnt(0)
    v_add_f32 v28, v28, v32
    v_add_f32 v29, v29, v33
    v_add_f32 v30, v30, v34
    v_add_f32 v31, v31, v35
    v_add_f32 v36, v36, v40
    v_add_f32 v37, v37, v41
    v_add_f32 v38, v38, v42
    v_add_f32 v39, v39, v43
    v_add_f32 v28, v28, v36
    v_add_f32 v29, v29, v37
    v_add_f32 v30, v30, v38
    v_add_f32 v31, v31, v39
    v_bfi_b32 v28, s95, v170, v28
    v_bfi_b32 v29, s95, v170, v29
    v_bfi_b32 v30, s95, v170, v30
    v_bfi_b32 v31, s95, v170, v31
    s_lshl_b32 s52, s34, 8
    v_add_u32 v100, s52, v13
    s_add_u32 s52, s100, 2048
    s_mov_b64 exec, 0xffff
    buffer_store_dwordx4 v[28:31], v100, s[36:39], s52 offen sc1
    s_mov_b64 exec, -1
    s_cmp_eq_u32 s99, 0
    s_cbranch_scc1 L_wo_10
    s_mov_b32 s48, s18
    s_mov_b32 s49, s19
    s_mov_b32 s50, 3456
    s_mov_b32 s51, 0x20000
    s_mul_i32 s52, s30, 108
    v_lshlrev_b32 v15, 3, v2
    v_add_u32 v15, s52, v15
    buffer_load_dwordx2 v[76:77], v15, s[48:51], 0 offen
    s_mov_b32 s48, s20
    s_mov_b32 s49, s21
    s_mov_b32 s50, 2211840
    s_mov_b32 s51, 0x20000
    s_mul_i32 s52, s30, 54
    s_lshl_b32 s53, s34, 4
    s_add_u32 s52, s52, s53
    s_mul_i32 s52, s52, 1280
    s_lshl_b32 s54, s98, 8
    s_add_u32 s52, s52, s54
    v_add_u32 v78, s53, v3
    v_add_u32 v88, s52, v14
    v_cmp_gt_u32 vcc, 54, v78
    v_mov_b32 v92, 0x7f000000
    s_add_u32 s52, s52, 5120
    v_cndmask_b32 v88, v92, v88, vcc
    v_add_u32 v89, s52, v14
    v_cmp_gt_u32 vcc, 50, v78
    v_mov_b32 v92, 0x7f000000
    s_add_u32 s52, s52, 5120
    v_cndmask_b32 v89, v92, v89, vcc
    v_add_u32 v90, s52, v14
    v_cmp_gt_u32 vcc, 46, v78
    v_mov_b32 v92, 0x7f000000
    s_add_u32 s52, s52, 5120
    v_cndmask_b32 v90, v92, v90, vcc
    v_add_u32 v91, s52, v14
    v_cmp_gt_u32 vcc, 42, v78
    v_mov_b32 v92, 0x7f000000
    s_add_u32 s52, s52, 5120
    v_cndmask_b32 v91, v92, v91, vcc
    buffer_load_dwordx4 v[16:19], v88, s[48:51], 0 offen nt
    buffer_load_dwordx4 v[20:23], v89, s[48:51], 0 offen nt
    buffer_load_dwordx4 v[24:27], v90, s[48:51], 0 offen nt
    buffer_load_dwordx4 v[28:31], v91, s[48:51], 0 offen nt
    s_cmp_lt_u32 s99, 2
    s_cbranch_scc1 L_u1_12
    buffer_load_dwordx4 v[32:35], v88, s[48:51], 0 offen offset:256 nt
    buffer_load_dwordx4 v[36:39], v89, s[48:51], 0 offen offset:256 nt
    buffer_load_dwordx4 v[40:43], v90, s[48:51], 0 offen offset:256 nt
    buffer_load_dwordx4 v[44:47], v91, s[48:51], 0 offen offset:256 nt
L_u1_12:
    s_lshl_b32 s52, s30, 15
    s_lshl_b32 s53, s34, 8
    s_add_u32 s52, s52, s53
    s_add_u32 s52, s52, 1050624
    v_lshlrev_b32 v128, 12, v3
    v_add_u32 v128, v128, v11
    s_mov_b32 s58, 0
L_pollh_13:
    buffer_load_dwordx4 v[112:115], v128, s[36:39], s52 offen sc1
    s_add_u32 s53, s52, 16384
    buffer_load_dwordx4 v[116:119], v128, s[36:39], s53 offen sc1
    s_waitcnt vmcnt(0)
    v_xor_b32 v130, v112, v170
    v_xor_b32 v131, v113, v170
    v_xor_b32 v132, v114, v170
    v_or3_b32 v130, v130, v131, v132
    v_xor_b32 v131, v115, v170
    v_xor_b32 v132, v116, v170
    v_or3_b32 v130, v130, v131, v132
    v_xor_b32 v131, v117, v170
    v_xor_b32 v132, v118, v170
    v_or3_b32 v130, v130, v131, v132
    v_xor_b32 v131, v119, v170
    v_or_b32 v130, v130, v131
    v_and_b32 v130, 15, v130
    v_cmp_ne_u32 vcc, 0, v130
    s_add_u32 s58, s58, 1
    s_cbranch_vccz L_pdoneh_14
    s_cmp_lt_u32 s58, 200000
    s_cbranch_scc0 L_pdoneh_14
    s_sleep 4
    s_branch L_pollh_13
L_pdoneh_14:
    v_add_f32 v112, v112, v116
    v_add_f32 v113, v113, v117
    v_add_f32 v114, v114, v118
    v_add_f32 v115, v115, v119
    v_mov_b32 v116, v112
    v_mov_b32 v117, v113
    v_mov_b32 v118, v114
    v_mov_b32 v119, v115
    s_nop 1
    v_permlane16_swap_b32 v112, v116
    v_permlane16_swap_b32 v113, v117
    v_permlane16_swap_b32 v114, v118
    v_permlane16_swap_b32 v115, v119
    s_nop 1
    v_add_f32 v112, v112, v116
    v_add_f32 v113, v113, v117
    v_add_f32 v114, v114, v118
    v_add_f32 v115, v115, v119
    v_mov_b32 v116, v112
    v_mov_b32 v117, v113
    v_mov_b32 v118, v114
    v_mov_b32 v119, v115
    s_nop 1
    v_permlane32_swap_b32 v112, v116
    v_permlane32_swap_b32 v113, v117
    v_permlane32_swap_b32 v114, v118
    v_permlane32_swap_b32 v115, v119
    s_nop 1
    v_add_f32 v112, v112, v116
    v_add_f32 v113, v113, v117
    v_add_f32 v114, v114, v118
    v_add_f32 v115, v115, v119
    v_lshlrev_b32 v52, 16, v76
    v_and_b32 v53, 0xffff0000, v76
    v_lshlrev_b32 v54, 16, v77
    v_and_b32 v55, 0xffff0000, v77
    v_cvt_pk_bf16_f32 v112, v112, v112
    v_and_b32 v112, 0xffff0000, v112
    v_cvt_pk_bf16_f32 v113, v113, v113
    v_and_b32 v113, 0xffff0000, v113
    v_cvt_pk_bf16_f32 v114, v114, v114
    v_and_b32 v114, 0xffff0000, v114
    v_cvt_pk_bf16_f32 v115, v115, v115
    v_and_b32 v115, 0xffff0000, v115
    v_add_f32 v112, v112, v52
    v_add_f32 v113, v113, v53
    v_add_f32 v114, v114, v54
    v_add_f32 v115, v115, v55
    v_cvt_pk_bf16_f32 v112, v112, v112
    v_and_b32 v112, 0xffff0000, v112
    v_cvt_pk_bf16_f32 v113, v113, v113
    v_and_b32 v113, 0xffff0000, v113
    v_cvt_pk_bf16_f32 v114, v114, v114
    v_and_b32 v114, 0xffff0000, v114
    v_cvt_pk_bf16_f32 v115, v115, v115
    v_and_b32 v115, 0xffff0000, v115
    v_max_f32 v112, 0, v112
    v_max_f32 v113, 0, v113
    v_max_f32 v114, 0, v114
    v_max_f32 v115, 0, v115
    v_mul_f32 v112, v112, v112
    v_mul_f32 v113, v113, v113
    v_mul_f32 v114, v114, v114
    v_mul_f32 v115, v115, v115
    v_cvt_pk_bf16_f32 v112, v112, v112
    v_cvt_pk_bf16_f32 v113, v113, v113
    v_cvt_pk_bf16_f32 v114, v114, v114
    v_cvt_pk_bf16_f32 v115, v115, v115
    v_lshlrev_b32 v52, 2, v2
    v_cmp_gt_u32 vcc, 54, v52
    s_nop 1
    v_cndmask_b32 v112, 0, v112, vcc
    v_cmp_gt_u32 vcc, 53, v52
    s_nop 1
    v_cndmask_b32 v113, 0, v113, vcc
    v_cmp_gt_u32 vcc, 52, v52
    s_nop 1
    v_cndmask_b32 v114, 0, v114, vcc
    v_cmp_gt_u32 vcc, 51, v52
    s_nop 1
    v_cndmask_b32 v115, 0, v115, vcc
    s_lshl_b32 s52, s34, 8
    v_add_u32 v101, s52, v11
    s_mov_b64 exec, 0xffff
    ds_write_b128 v101, v[112:115] offset:18944
    s_mov_b64 exec, -1
    s_waitcnt lgkmcnt(0)
    v_mov_b32 v173, 19976
    v_mov_b32 v174, 1
    s_mov_b64 exec, 1
    ds_add_u32 v173, v174
L_lw_15:
    ds_read_b32 v174, v173
    s_waitcnt lgkmcnt(0)
    v_readfirstlane_b32 s59, v174
    s_cmp_lt_u32 s59, 4
    s_cbranch_scc1 L_lw_15
    s_mov_b64 exec, -1
    v_lshlrev_b32 v79, 8, v12
    v_lshlrev_b32 v78, 2, v78
    v_add_u32 v78, v78, v79
    s_waitcnt vmcnt(0)
    ds_read_b32 v48, v78 offset:18944
    ds_read_b32 v49, v78 offset:19456
    ds_read_b32 v50, v78 offset:18960
    ds_read_b32 v51, v78 offset:19472
    ds_read_b32 v52, v78 offset:18976
    ds_read_b32 v53, v78 offset:19488
    ds_read_b32 v54, v78 offset:18992
    ds_read_b32 v55, v78 offset:19504
    s_waitcnt lgkmcnt(7)
    v_and_b32 v56, v104, v48
    v_and_b32 v57, v105, v48
    v_and_b32 v58, v106, v48
    v_and_b32 v59, v107, v48
    s_nop 1
    v_mfma_f32_16x16x32_bf16 v[80:83], v[56:59], v[16:19], 0
    v_mfma_f32_16x16x32_bf16 v[92:95], v[56:59], v[32:35], 0
    s_waitcnt lgkmcnt(6)
    v_and_b32 v60, v104, v49
    v_and_b32 v61, v105, v49
    v_and_b32 v62, v106, v49
    v_and_b32 v63, v107, v49
    s_nop 1
    v_mfma_f32_16x16x32_bf16 v[84:87], v[60:63], v[16:19], 0
    v_mfma_f32_16x16x32_bf16 v[96:99], v[60:63], v[32:35], 0
    s_waitcnt lgkmcnt(5)
    v_and_b32 v56, v104, v50
    v_and_b32 v57, v105, v50
    v_and_b32 v58, v106, v50
    v_and_b32 v59, v107, v50
    s_nop 1
    v_mfma_f32_16x16x32_bf16 v[80:83], v[56:59], v[20:23], v[80:83]
    v_mfma_f32_16x16x32_bf16 v[92:95], v[56:59], v[36:39], v[92:95]
    s_waitcnt lgkmcnt(4)
    v_and_b32 v60, v104, v51
    v_and_b32 v61, v105, v51
    v_and_b32 v62, v106, v51
    v_and_b32 v63, v107, v51
    s_nop 1
    v_mfma_f32_16x16x32_bf16 v[84:87], v[60:63], v[20:23], v[84:87]
    v_mfma_f32_16x16x32_bf16 v[96:99], v[60:63], v[36:39], v[96:99]
    s_waitcnt lgkmcnt(3)
    v_and_b32 v56, v104, v52
    v_and_b32 v57, v105, v52
    v_and_b32 v58, v106, v52
    v_and_b32 v59, v107, v52
    s_nop 1
    v_mfma_f32_16x16x32_bf16 v[80:83], v[56:59], v[24:27], v[80:83]
    v_mfma_f32_16x16x32_bf16 v[92:95], v[56:59], v[40:43], v[92:95]
    s_waitcnt lgkmcnt(2)
    v_and_b32 v60, v104, v53
    v_and_b32 v61, v105, v53
    v_and_b32 v62, v106, v53
    v_and_b32 v63, v107, v53
    s_nop 1
    v_mfma_f32_16x16x32_bf16 v[84:87], v[60:63], v[24:27], v[84:87]
    v_mfma_f32_16x16x32_bf16 v[96:99], v[60:63], v[40:43], v[96:99]
    s_waitcnt lgkmcnt(1)
    v_and_b32 v56, v104, v54
    v_and_b32 v57, v105, v54
    v_and_b32 v58, v106, v54
    v_and_b32 v59, v107, v54
    s_nop 1
    v_mfma_f32_16x16x32_bf16 v[80:83], v[56:59], v[28:31], v[80:83]
    v_mfma_f32_16x16x32_bf16 v[92:95], v[56:59], v[44:47], v[92:95]
    s_waitcnt lgkmcnt(0)
    v_and_b32 v60, v104, v55
    v_and_b32 v61, v105, v55
    v_and_b32 v62, v106, v55
    v_and_b32 v63, v107, v55
    s_nop 1
    v_mfma_f32_16x16x32_bf16 v[84:87], v[60:63], v[28:31], v[84:87]
    v_mfma_f32_16x16x32_bf16 v[96:99], v[60:63], v[44:47], v[96:99]
    s_nop 7
    s_lshl_b32 s52, s34, 11
    v_add_u32 v100, s52, v103
    ds_write_b128 v100, v[80:83] offset:2048
    ds_write_b128 v100, v[84:87] offset:3072
    ds_write_b128 v100, v[92:95] offset:10240
    ds_write_b128 v100, v[96:99] offset:11264
    s_waitcnt lgkmcnt(0)
    v_mov_b32 v173, 19980
    v_mov_b32 v174, 1
    s_mov_b64 exec, 1
    ds_add_u32 v173, v174
L_lw_16:
    ds_read_b32 v174, v173
    s_waitcnt lgkmcnt(0)
    v_readfirstlane_b32 s59, v174
    s_cmp_lt_u32 s59, 4
    s_cbranch_scc1 L_lw_16
    s_mov_b64 exec, -1
    v_lshrrev_b32 v108, 5, v1
    v_mul_u32_u24 v110, 8192, v108
    v_and_b32 v109, 31, v1
    s_lshl_b32 s52, s34, 5
    v_add_u32 v109, s52, v109
    v_lshlrev_b32 v111, 2, v109
    v_add_u32 v110, v110, v111
    ds_read_b32 v112, v110 offset:2048
    ds_read_b32 v113, v110 offset:2560
    ds_read_b32 v114, v110 offset:3072
    ds_read_b32 v115, v110 offset:3584
    ds_read_b32 v116, v110 offset:4096
    ds_read_b32 v117, v110 offset:4608
    ds_read_b32 v118, v110 offset:5120
    ds_read_b32 v119, v110 offset:5632
    ds_read_b32 v120, v110 offset:6144
    ds_read_b32 v121, v110 offset:6656
    ds_read_b32 v122, v110 offset:7168
    ds_read_b32 v123, v110 offset:7680
    ds_read_b32 v124, v110 offset:8192
    ds_read_b32 v125, v110 offset:8704
    ds_read_b32 v126, v110 offset:9216
    ds_read_b32 v127, v110 offset:9728
    s_waitcnt lgkmcnt(0)
    v_add_f32 v112, v112, v116
    v_add_f32 v113, v113, v117
    v_add_f32 v114, v114, v118
    v_add_f32 v115, v115, v119
    v_add_f32 v120, v120, v124
    v_add_f32 v121, v121, v125
    v_add_f32 v122, v122, v126
    v_add_f32 v123, v123, v127
    v_add_f32 v112, v112, v120
    v_add_f32 v113, v113, v121
    v_add_f32 v114, v114, v122
    v_add_f32 v115, v115, v123
    v_bfi_b32 v112, s95, v170, v112
    v_bfi_b32 v113, s95, v170, v113
    v_bfi_b32 v114, s95, v170, v114
    v_bfi_b32 v115, s95, v170, v115
    s_add_u32 s52, s56, s98
    s_lshl_b32 s52, s52, 11
    s_add_u32 s52, s52, 5242880
    v_lshlrev_b32 v110, 11, v108
    v_lshlrev_b32 v111, 4, v109
    v_add_u32 v110, v110, v111
    s_cmp_lt_u32 s99, 2
    s_cselect_b32 exec_hi, 0, -1
    buffer_store_dwordx4 v[112:115], v110, s[36:39], s52 offen sc1
    s_mov_b64 exec, -1
    s_cmp_ge_u32 s62, 80
    s_cbranch_scc1 L_b3_11
    s_cmp_lg_u32 s34, 0
    s_cbranch_scc1 L_b3_11
    s_lshr_b32 s54, s62, 4
    s_and_b32 s53, s62, 15
    s_lshl_b32 s55, s54, 11
    s_lshl_b32 s63, s53, 7
    s_add_u32 s55, s55, s63
    s_lshl_b32 s63, s62, 4
    v_lshrrev_b32 v88, 3, v1
    v_and_b32 v89, 7, v1
    v_lshlrev_b32 v90, 4, v89
    v_lshlrev_b32 v91, 1, v89
    v_add_u32 v91, s63, v91
    s_mov_b32 s48, s22
    s_mov_b32 s49, s23
    s_mov_b32 s50, 1280
    s_mov_b32 s51, 0x20000
    buffer_load_ushort v94, v91, s[48:51], 0 offen
    buffer_load_ushort v80, v91, s[40:43], 0 offen offset:0
    buffer_load_ushort v81, v91, s[40:43], 0 offen offset:1280
    buffer_load_ushort v82, v91, s[40:43], 0 offen offset:2560
    buffer_load_ushort v83, v91, s[40:43], 0 offen offset:3840
    v_mul_u32_u24 v93, 10240, v88
    v_add_u32 v93, v93, v90
    s_mov_b32 s58, 0
L_pollym_17:
    s_add_u32 s52, s55, 5242880
    buffer_load_dwordx4 v[16:19], v93, s[36:39], s52 offen sc1
    s_add_u32 s52, s52, 81920
    buffer_load_dwordx4 v[20:23], v93, s[36:39], s52 offen sc1
    s_add_u32 s52, s52, 81920
    buffer_load_dwordx4 v[24:27], v93, s[36:39], s52 offen sc1
    s_add_u32 s52, s52, 81920
    buffer_load_dwordx4 v[28:31], v93, s[36:39], s52 offen sc1
    s_waitcnt vmcnt(0)
    v_xor_b32 v126, v16, v170
    v_xor_b32 v127, v17, v170
    v_xor_b32 v128, v18, v170
    v_or3_b32 v126, v126, v127, v128
    v_xor_b32 v127, v19, v170
    v_xor_b32 v128, v20, v170
    v_or3_b32 v126, v126, v127, v128
    v_xor_b32 v127, v21, v170
    v_xor_b32 v128, v22, v170
    v_or3_b32 v126, v126, v127, v128
    v_xor_b32 v127, v23, v170
    v_xor_b32 v128, v24, v170
    v_or3_b32 v126, v126, v127, v128
    v_xor_b32 v127, v25, v170
    v_xor_b32 v128, v26, v170
    v_or3_b32 v126, v126, v127, v128
    v_xor_b32 v127, v27, v170
    v_xor_b32 v128, v28, v170
    v_or3_b32 v126, v126, v127, v128
    v_xor_b32 v127, v29, v170
    v_xor_b32 v128, v30, v170
    v_or3_b32 v126, v126, v127, v128
    v_xor_b32 v127, v31, v170
    v_or_b32 v126, v126, v127
    v_and_b32 v126, 15, v126
    v_cmp_ne_u32 vcc, 0, v126
    s_add_u32 s58, s58, 1
    s_cbranch_vccz L_pdoneym_18
    s_cmp_lt_u32 s58, 200000
    s_cbranch_scc0 L_pdoneym_18
    s_sleep 8
    s_branch L_pollym_17
L_pdoneym_18:
    v_add_f32 v16, v16, v20
    v_add_f32 v17, v17, v21
    v_add_f32 v18, v18, v22
    v_add_f32 v19, v19, v23
    v_add_f32 v16, v16, v24
    v_add_f32 v17, v17, v25
    v_add_f32 v18, v18, v26
    v_add_f32 v19, v19, v27
    v_add_f32 v16, v16, v28
    v_add_f32 v17, v17, v29
    v_add_f32 v18, v18, v30
    v_add_f32 v19, v19, v31
    s_nop 1
    v_add_f32_dpp v16, v16, v16 row_ror:8 row_mask:0xf bank_mask:0xf
    v_add_f32_dpp v17, v17, v17 row_ror:8 row_mask:0xf bank_mask:0xf
    v_add_f32_dpp v18, v18, v18 row_ror:8 row_mask:0xf bank_mask:0xf
    v_add_f32_dpp v19, v19, v19 row_ror:8 row_mask:0xf bank_mask:0xf
    v_mov_b32 v20, v16
    v_mov_b32 v21, v17
    v_mov_b32 v22, v18
    v_mov_b32 v23, v19
    s_nop 1
    v_permlane16_swap_b32 v16, v20
    v_permlane16_swap_b32 v17, v21
    v_permlane16_swap_b32 v18, v22
    v_permlane16_swap_b32 v19, v23
    s_nop 1
    v_add_f32 v16, v16, v20
    v_add_f32 v17, v17, v21
    v_add_f32 v18, v18, v22
    v_add_f32 v19, v19, v23
    v_mov_b32 v20, v16
    v_mov_b32 v21, v17
    v_mov_b32 v22, v18
    v_mov_b32 v23, v19
    s_nop 1
    v_permlane32_swap_b32 v16, v20
    v_permlane32_swap_b32 v17, v21
    v_permlane32_swap_b32 v18, v22
    v_permlane32_swap_b32 v19, v23
    s_nop 1
    v_add_f32 v16, v16, v20
    v_add_f32 v17, v17, v21
    v_add_f32 v18, v18, v22
    v_add_f32 v19, v19, v23
    v_lshlrev_b32 v80, 16, v80
    v_lshlrev_b32 v81, 16, v81
    v_lshlrev_b32 v82, 16, v82
    v_lshlrev_b32 v83, 16, v83
    v_lshlrev_b32 v94, 16, v94
    v_cvt_pk_bf16_f32 v16, v16, v16
    v_and_b32 v16, 0xffff0000, v16
    v_cvt_pk_bf16_f32 v17, v17, v17
    v_and_b32 v17, 0xffff0000, v17
    v_cvt_pk_bf16_f32 v18, v18, v18
    v_and_b32 v18, 0xffff0000, v18
    v_cvt_pk_bf16_f32 v19, v19, v19
    v_and_b32 v19, 0xffff0000, v19
    v_add_f32 v84, v16, v94
    v_add_f32 v85, v17, v94
    v_add_f32 v86, v18, v94
    v_add_f32 v87, v19, v94
    v_cvt_pk_bf16_f32 v84, v84, v84
    v_and_b32 v84, 0xffff0000, v84
    v_cvt_pk_bf16_f32 v85, v85, v85
    v_and_b32 v85, 0xffff0000, v85
    v_cvt_pk_bf16_f32 v86, v86, v86
    v_and_b32 v86, 0xffff0000, v86
    v_cvt_pk_bf16_f32 v87, v87, v87
    v_and_b32 v87, 0xffff0000, v87
    s_branch L_b3_11
L_wo_10:
    s_mov_b32 s48, s12
    s_mov_b32 s49, s13
    s_mov_b32 s50, 5242880
    s_mov_b32 s51, 0x20000
    s_lshl_b32 s52, s30, 7
    s_mul_i32 s52, s52, 1280
    s_lshl_b32 s53, s97, 8
    s_add_u32 s52, s52, s53
    s_lshl_b32 s53, s34, 6
    s_add_u32 s52, s52, s53
    v_lshrrev_b32 v78, 2, v1
    v_mul_u32_u24 v78, 1280, v78
    v_and_b32 v79, 3, v1
    v_lshlrev_b32 v79, 4, v79
    v_add_u32 v78, v78, v79
    buffer_load_dwordx4 v[16:19], v78, s[48:51], s52 offen nt
    s_add_u32 s52, s52, 20480
    buffer_load_dwordx4 v[20:23], v78, s[48:51], s52 offen nt
    s_add_u32 s52, s52, 20480
    buffer_load_dwordx4 v[24:27], v78, s[48:51], s52 offen nt
    s_add_u32 s52, s52, 20480
    buffer_load_dwordx4 v[28:31], v78, s[48:51], s52 offen nt
    s_add_u32 s52, s52, 20480
    buffer_load_dwordx4 v[32:35], v78, s[48:51], s52 offen nt
    s_add_u32 s52, s52, 20480
    buffer_load_dwordx4 v[36:39], v78, s[48:51], s52 offen nt
    s_add_u32 s52, s52, 20480
    buffer_load_dwordx4 v[40:43], v78, s[48:51], s52 offen nt
    s_add_u32 s52, s52, 20480
    buffer_load_dwordx4 v[44:47], v78, s[48:51], s52 offen nt
    s_lshl_b32 s52, s34, 13
    v_add_u32 v79, s52, v8
    v_mov_b32 v88, 0
    v_mov_b32 v89, 0
    v_mov_b32 v90, 0
    v_mov_b32 v91, 0
    s_mov_b64 exec, 0xffff
    ds_write_b128 v8, v[88:91] offset:29952
    s_mov_b64 exec, -1
    s_waitcnt vmcnt(7)
    ds_write_b128 v79, v[16:19] offset:30720
    s_waitcnt vmcnt(6)
    ds_write_b128 v79, v[20:23] offset:31744
    s_waitcnt vmcnt(5)
    ds_write_b128 v79, v[24:27] offset:32768
    s_waitcnt vmcnt(4)
    ds_write_b128 v79, v[28:31] offset:33792
    s_waitcnt vmcnt(3)
    ds_write_b128 v79, v[32:35] offset:34816
    s_waitcnt vmcnt(2)
    ds_write_b128 v79, v[36:39] offset:35840
    s_waitcnt vmcnt(1)
    ds_write_b128 v79, v[40:43] offset:36864
    s_waitcnt vmcnt(0)
    ds_write_b128 v79, v[44:47] offset:37888
    v_lshlrev_b32 v78, 9, v3
    v_lshlrev_b32 v79, 1, v2
    v_add_u32 v78, v78, v79
    v_add_u32 v78, s52, v78
    s_waitcnt lgkmcnt(0)
    ds_read_u16 v16, v78 offset:30720
    ds_read_u16 v112, v78 offset:30784
    ds_read_u16 v17, v78 offset:30848
    ds_read_u16 v113, v78 offset:30912
    ds_read_u16 v18, v78 offset:30976
    ds_read_u16 v114, v78 offset:31040
    ds_read_u16 v19, v78 offset:31104
    ds_read_u16 v115, v78 offset:31168
    ds_read_u16 v20, v78 offset:30752
    ds_read_u16 v116, v78 offset:30816
    ds_read_u16 v21, v78 offset:30880
    ds_read_u16 v117, v78 offset:30944
    ds_read_u16 v22, v78 offset:31008
    ds_read_u16 v118, v78 offset:31072
    ds_read_u16 v23, v78 offset:31136
    ds_read_u16 v119, v78 offset:31200
    s_waitcnt lgkmcnt(0)
    v_lshl_or_b32 v16, v112, 16, v16
    v_lshl_or_b32 v17, v113, 16, v17
    v_lshl_or_b32 v18, v114, 16, v18
    v_lshl_or_b32 v19, v115, 16, v19
    v_lshl_or_b32 v20, v116, 16, v20
    v_lshl_or_b32 v21, v117, 16, v21
    v_lshl_or_b32 v22, v118, 16, v22
    v_lshl_or_b32 v23, v119, 16, v23
    ds_read_u16 v24, v78 offset:32768
    ds_read_u16 v112, v78 offset:32832
    ds_read_u16 v25, v78 offset:32896
    ds_read_u16 v113, v78 offset:32960
    ds_read_u16 v26, v78 offset:33024
    ds_read_u16 v114, v78 offset:33088
    ds_read_u16 v27, v78 offset:33152
    ds_read_u16 v115, v78 offset:33216
    ds_read_u16 v28, v78 offset:32800
    ds_read_u16 v116, v78 offset:32864
    ds_read_u16 v29, v78 offset:32928
    ds_read_u16 v117, v78 offset:32992
    ds_read_u16 v30, v78 offset:33056
    ds_read_u16 v118, v78 offset:33120
    ds_read_u16 v31, v78 offset:33184
    ds_read_u16 v119, v78 offset:33248
    s_waitcnt lgkmcnt(0)
    v_lshl_or_b32 v24, v112, 16, v24
    v_lshl_or_b32 v25, v113, 16, v25
    v_lshl_or_b32 v26, v114, 16, v26
    v_lshl_or_b32 v27, v115, 16, v27
    v_lshl_or_b32 v28, v116, 16, v28
    v_lshl_or_b32 v29, v117, 16, v29
    v_lshl_or_b32 v30, v118, 16, v30
    v_lshl_or_b32 v31, v119, 16, v31
    ds_read_u16 v32, v78 offset:34816
    ds_read_u16 v112, v78 offset:34880
    ds_read_u16 v33, v78 offset:34944
    ds_read_u16 v113, v78 offset:35008
    ds_read_u16 v34, v78 offset:35072
    ds_read_u16 v114, v78 offset:35136
    ds_read_u16 v35, v78 offset:35200
    ds_read_u16 v115, v78 offset:35264
    ds_read_u16 v36, v78 offset:34848
    ds_read_u16 v116, v78 offset:34912
    ds_read_u16 v37, v78 offset:34976
    ds_read_u16 v117, v78 offset:35040
    ds_read_u16 v38, v78 offset:35104
    ds_read_u16 v118, v78 offset:35168
    ds_read_u16 v39, v78 offset:35232
    ds_read_u16 v119, v78 offset:35296
    s_waitcnt lgkmcnt(0)
    v_lshl_or_b32 v32, v112, 16, v32
    v_lshl_or_b32 v33, v113, 16, v33
    v_lshl_or_b32 v34, v114, 16, v34
    v_lshl_or_b32 v35, v115, 16, v35
    v_lshl_or_b32 v36, v116, 16, v36
    v_lshl_or_b32 v37, v117, 16, v37
    v_lshl_or_b32 v38, v118, 16, v38
    v_lshl_or_b32 v39, v119, 16, v39
    ds_read_u16 v40, v78 offset:36864
    ds_read_u16 v112, v78 offset:36928
    ds_read_u16 v41, v78 offset:36992
    ds_read_u16 v113, v78 offset:37056
    ds_read_u16 v42, v78 offset:37120
    ds_read_u16 v114, v78 offset:37184
    ds_read_u16 v43, v78 offset:37248
    ds_read_u16 v115, v78 offset:37312
    ds_read_u16 v44, v78 offset:36896
    ds_read_u16 v116, v78 offset:36960
    ds_read_u16 v45, v78 offset:37024
    ds_read_u16 v117, v78 offset:37088
    ds_read_u16 v46, v78 offset:37152
    ds_read_u16 v118, v78 offset:37216
    ds_read_u16 v47, v78 offset:37280
    ds_read_u16 v119, v78 offset:37344
    s_waitcnt lgkmcnt(0)
    v_lshl_or_b32 v40, v112, 16, v40
    v_lshl_or_b32 v41, v113, 16, v41
    v_lshl_or_b32 v42, v114, 16, v42
    v_lshl_or_b32 v43, v115, 16, v43
    v_lshl_or_b32 v44, v116, 16, v44
    v_lshl_or_b32 v45, v117, 16, v45
    v_lshl_or_b32 v46, v118, 16, v46
    v_lshl_or_b32 v47, v119, 16, v47
    v_lshlrev_b32 v78, 8, v2
    v_lshlrev_b32 v79, 4, v3
    v_add_u32 v78, v78, v79
    v_cmp_gt_u32 vcc, 4, v2
    v_mov_b32 v79, 1024
    s_nop 0
    v_cndmask_b32 v78, v79, v78, vcc
L_b3_11:
    s_barrier
    s_cmp_lg_u32 s34, 0
    s_cbranch_scc1 L_t1_19
    v_lshrrev_b32 v108, 5, v1
    v_lshlrev_b32 v110, 11, v108
    v_add_u32 v110, v110, v13
    v_lshlrev_b32 v160, 5, v108
    ds_read_b128 v[144:147], v160 offset:28672
    ds_read_b128 v[148:151], v160 offset:28688
    ds_read_b128 v[152:155], v160 offset:28736
    ds_read_b128 v[156:159], v160 offset:28752
    ds_read_b128 v[112:115], v110 offset:20480
    ds_read_b128 v[116:119], v110 offset:20992
    ds_read_b128 v[120:123], v110 offset:21504
    ds_read_b128 v[124:127], v110 offset:22016
    ds_read_b128 v[128:131], v110 offset:24576
    ds_read_b128 v[132:135], v110 offset:25088
    ds_read_b128 v[136:139], v110 offset:25600
    ds_read_b128 v[140:143], v110 offset:26112
    s_waitcnt lgkmcnt(8)
    v_max3_f32 v161, v144, v146, v148
    v_max3_f32 v161, v161, v150, v152
    v_max3_f32 v161, v161, v154, v156
    v_max_f32 v161, v161, v158
    v_sub_f32 v144, v144, v161
    v_sub_f32 v146, v146, v161
    v_sub_f32 v148, v148, v161
    v_sub_f32 v150, v150, v161
    v_sub_f32 v152, v152, v161
    v_sub_f32 v154, v154, v161
    v_sub_f32 v156, v156, v161
    v_sub_f32 v158, v158, v161
    v_mul_f32 v144, 0x3fb8aa3b, v144
    v_mul_f32 v146, 0x3fb8aa3b, v146
    v_mul_f32 v148, 0x3fb8aa3b, v148
    v_mul_f32 v150, 0x3fb8aa3b, v150
    v_mul_f32 v152, 0x3fb8aa3b, v152
    v_mul_f32 v154, 0x3fb8aa3b, v154
    v_mul_f32 v156, 0x3fb8aa3b, v156
    v_mul_f32 v158, 0x3fb8aa3b, v158
    v_exp_f32 v144, v144
    v_exp_f32 v146, v146
    v_exp_f32 v148, v148
    v_exp_f32 v150, v150
    v_exp_f32 v152, v152
    v_exp_f32 v154, v154
    v_exp_f32 v156, v156
    v_exp_f32 v158, v158
    s_nop 0
    v_mul_f32 v162, v144, v145
    v_fmac_f32 v162, v146, v147
    v_fmac_f32 v162, v148, v149
    v_fmac_f32 v162, v150, v151
    v_fmac_f32 v162, v152, v153
    v_fmac_f32 v162, v154, v155
    v_fmac_f32 v162, v156, v157
    v_fmac_f32 v162, v158, v159
    s_waitcnt lgkmcnt(0)
    v_mul_f32 v164, v112, v144
    v_mul_f32 v165, v113, v144
    v_mul_f32 v166, v114, v144
    v_mul_f32 v167, v115, v144
    v_fmac_f32 v164, v116, v146
    v_fmac_f32 v165, v117, v146
    v_fmac_f32 v166, v118, v146
    v_fmac_f32 v167, v119, v146
    v_fmac_f32 v164, v120, v148
    v_fmac_f32 v165, v121, v148
    v_fmac_f32 v166, v122, v148
    v_fmac_f32 v167, v123, v148
    v_fmac_f32 v164, v124, v150
    v_fmac_f32 v165, v125, v150
    v_fmac_f32 v166, v126, v150
    v_fmac_f32 v167, v127, v150
    v_fmac_f32 v164, v128, v152
    v_fmac_f32 v165, v129, v152
    v_fmac_f32 v166, v130, v152
    v_fmac_f32 v167, v131, v152
    v_fmac_f32 v164, v132, v154
    v_fmac_f32 v165, v133, v154
    v_fmac_f32 v166, v134, v154
    v_fmac_f32 v167, v135, v154
    v_fmac_f32 v164, v136, v156
    v_fmac_f32 v165, v137, v156
    v_fmac_f32 v166, v138, v156
    v_fmac_f32 v167, v139, v156
    v_fmac_f32 v164, v140, v158
    v_fmac_f32 v165, v141, v158
    v_fmac_f32 v166, v142, v158
    v_fmac_f32 v167, v143, v158
    v_bfi_b32 v164, s95, v170, v164
    v_bfi_b32 v165, s95, v170, v165
    v_bfi_b32 v166, s95, v170, v166
    v_bfi_b32 v167, s95, v170, v167
    v_lshlrev_b32 v163, 12, v108
    v_add_u32 v163, v163, v13
    buffer_store_dwordx4 v[164:167], v163, s[36:39], s57 offen sc1
    v_mov_b32 v168, v161
    v_mov_b32 v169, v162
    v_bfi_b32 v168, s95, v170, v168
    v_bfi_b32 v169, s95, v170, v169
    s_mov_b32 exec_lo, 1
    s_mov_b32 exec_hi, 1
    buffer_store_dwordx2 v[168:169], v163, s[36:39], s57 offen offset:512 sc1
    s_mov_b64 exec, -1
L_t1_19:
    s_cmp_ge_u32 s97, 5
    s_cbranch_scc1 L_notunit_20
    v_lshrrev_b32 v108, 5, v1
    v_lshlrev_b32 v110, 10, v108
    v_add_u32 v111, v110, v13
    s_lshl_b32 s52, s30, 2
    s_add_u32 s52, s52, s34
    s_lshl_b32 s52, s52, 12
    s_add_u32 s59, s52, 3145728
    s_mov_b32 s58, 0
L_pollh1_21:
    buffer_load_dwordx4 v[112:115], v111, s[36:39], s59 offen sc1
    buffer_load_dwordx4 v[116:119], v111, s[36:39], s59 offen offset:2048 sc1
    buffer_load_dwordx2 v[120:121], v110, s[36:39], s59 offen offset:512 sc1
    buffer_load_dwordx2 v[122:123], v110, s[36:39], s59 offen offset:2560 sc1
    s_waitcnt vmcnt(0)
    v_xor_b32 v126, v112, v170
    v_xor_b32 v127, v113, v170
    v_xor_b32 v128, v114, v170
    v_or3_b32 v126, v126, v127, v128
    v_xor_b32 v127, v115, v170
    v_xor_b32 v128, v116, v170
    v_or3_b32 v126, v126, v127, v128
    v_xor_b32 v127, v117, v170
    v_xor_b32 v128, v118, v170
    v_or3_b32 v126, v126, v127, v128
    v_xor_b32 v127, v119, v170
    v_xor_b32 v128, v120, v170
    v_or3_b32 v126, v126, v127, v128
    v_xor_b32 v127, v121, v170
    v_xor_b32 v128, v122, v170
    v_or3_b32 v126, v126, v127, v128
    v_xor_b32 v127, v123, v170
    v_or_b32 v126, v126, v127
    v_and_b32 v126, 15, v126
    v_cmp_ne_u32 vcc, 0, v126
    s_add_u32 s58, s58, 1
    s_cbranch_vccz L_pdoneh1_22
    s_cmp_lt_u32 s58, 200000
    s_cbranch_scc0 L_pdoneh1_22
    s_branch L_pollh1_21
L_pdoneh1_22:
    v_and_b32 v120, 0xffffff00, v120
    v_and_b32 v122, 0xffffff00, v122
    v_max_f32 v124, v120, v122
    v_mov_b32 v125, v124
    s_nop 1
    v_permlane32_swap_b32 v124, v125
    s_nop 1
    v_max_f32 v124, v124, v125
    v_sub_f32 v120, v120, v124
    v_sub_f32 v122, v122, v124
    v_mul_f32 v120, 0x3fb8aa3b, v120
    v_mul_f32 v122, 0x3fb8aa3b, v122
    v_exp_f32 v120, v120
    v_exp_f32 v122, v122
    s_nop 0
    v_mul_f32 v128, v120, v121
    v_fmac_f32 v128, v122, v123
    v_mul_f32 v129, v112, v120
    v_mul_f32 v130, v113, v120
    v_mul_f32 v131, v114, v120
    v_mul_f32 v132, v115, v120
    v_fmac_f32 v129, v116, v122
    v_fmac_f32 v130, v117, v122
    v_fmac_f32 v131, v118, v122
    v_fmac_f32 v132, v119, v122
    v_mov_b32 v134, v128
    v_mov_b32 v135, v129
    v_mov_b32 v136, v130
    v_mov_b32 v137, v131
    v_mov_b32 v138, v132
    s_nop 1
    v_permlane32_swap_b32 v128, v134
    v_permlane32_swap_b32 v129, v135
    v_permlane32_swap_b32 v130, v136
    v_permlane32_swap_b32 v131, v137
    v_permlane32_swap_b32 v132, v138
    s_nop 1
    v_add_f32 v128, v128, v134
    v_add_f32 v129, v129, v135
    v_add_f32 v130, v130, v136
    v_add_f32 v131, v131, v137
    v_add_f32 v132, v132, v138
    v_rcp_f32 v133, v128
    s_nop 0
    v_mul_f32 v134, v129, v133
    v_mul_f32 v135, v130, v133
    v_mul_f32 v136, v131, v133
    v_mul_f32 v137, v132, v133
    v_fma_f32 v138, -v134, v128, v129
    v_fma_f32 v139, -v135, v128, v130
    v_fma_f32 v140, -v136, v128, v131
    v_fma_f32 v141, -v137, v128, v132
    v_fma_f32 v134, v138, v133, v134
    v_fma_f32 v135, v139, v133, v135
    v_fma_f32 v136, v140, v133, v136
    v_fma_f32 v137, v141, v133, v137
    v_cvt_pk_bf16_f32 v140, v134, v135
    v_cvt_pk_bf16_f32 v141, v136, v137
    v_lshrrev_b32 v134, 1, v13
    s_lshl_b32 s52, s34, 8
    v_add_u32 v134, s52, v134
    ds_write_b64 v134, v[140:141] offset:28928
    s_add_u32 s52, s56, s97
    s_lshl_b32 s52, s52, 11
    s_lshl_b32 s53, s34, 9
    s_add_u32 s52, s52, s53
    s_add_u32 s52, s52, 4194304
    s_waitcnt lgkmcnt(0)
    s_barrier
    ds_read_b128 v[112:115], v78 offset:28928
    ds_read_b128 v[116:119], v78 offset:28992
    ds_read_b128 v[120:123], v78 offset:29056
    ds_read_b128 v[124:127], v78 offset:29120
    s_waitcnt lgkmcnt(3)
    v_mfma_f32_16x16x32_bf16 v[80:83], v[112:115], v[16:19], 0
    v_mfma_f32_16x16x32_bf16 v[84:87], v[112:115], v[20:23], 0
    s_waitcnt lgkmcnt(2)
    v_mfma_f32_16x16x32_bf16 v[80:83], v[116:119], v[24:27], v[80:83]
    v_mfma_f32_16x16x32_bf16 v[84:87], v[116:119], v[28:31], v[84:87]
    s_waitcnt lgkmcnt(1)
    v_mfma_f32_16x16x32_bf16 v[80:83], v[120:123], v[32:35], v[80:83]
    v_mfma_f32_16x16x32_bf16 v[84:87], v[120:123], v[36:39], v[84:87]
    s_waitcnt lgkmcnt(0)
    v_mfma_f32_16x16x32_bf16 v[80:83], v[124:127], v[40:43], v[80:83]
    v_mfma_f32_16x16x32_bf16 v[84:87], v[124:127], v[44:47], v[84:87]
    s_nop 7
    v_bfi_b32 v80, s95, v170, v80
    v_bfi_b32 v81, s95, v170, v81
    v_bfi_b32 v82, s95, v170, v82
    v_bfi_b32 v83, s95, v170, v83
    v_bfi_b32 v84, s95, v170, v84
    v_bfi_b32 v85, s95, v170, v85
    v_bfi_b32 v86, s95, v170, v86
    v_bfi_b32 v87, s95, v170, v87
    s_mov_b64 exec, 0xffff
    buffer_store_dwordx4 v[80:83], v11, s[36:39], s52 offen sc1
    buffer_store_dwordx4 v[84:87], v11, s[36:39], s52 offen offset:256 sc1
    s_mov_b64 exec, -1
    s_endpgm
L_notunit_20:
    s_cmp_lg_u32 s34, 0
    s_cbranch_scc1 L_end
    s_cmp_ge_u32 s62, 80
    s_cbranch_scc1 L_stonly_23
    s_mov_b32 s58, 0
L_polly_24:
    s_add_u32 s52, s55, 4194304
    buffer_load_dwordx4 v[16:19], v93, s[36:39], s52 offen sc1
    s_add_u32 s52, s52, 81920
    buffer_load_dwordx4 v[20:23], v93, s[36:39], s52 offen sc1
    s_add_u32 s52, s52, 81920
    buffer_load_dwordx4 v[24:27], v93, s[36:39], s52 offen sc1
    s_add_u32 s52, s52, 81920
    buffer_load_dwordx4 v[28:31], v93, s[36:39], s52 offen sc1
    s_waitcnt vmcnt(0)
    v_xor_b32 v126, v16, v170
    v_xor_b32 v127, v17, v170
    v_xor_b32 v128, v18, v170
    v_or3_b32 v126, v126, v127, v128
    v_xor_b32 v127, v19, v170
    v_xor_b32 v128, v20, v170
    v_or3_b32 v126, v126, v127, v128
    v_xor_b32 v127, v21, v170
    v_xor_b32 v128, v22, v170
    v_or3_b32 v126, v126, v127, v128
    v_xor_b32 v127, v23, v170
    v_xor_b32 v128, v24, v170
    v_or3_b32 v126, v126, v127, v128
    v_xor_b32 v127, v25, v170
    v_xor_b32 v128, v26, v170
    v_or3_b32 v126, v126, v127, v128
    v_xor_b32 v127, v27, v170
    v_xor_b32 v128, v28, v170
    v_or3_b32 v126, v126, v127, v128
    v_xor_b32 v127, v29, v170
    v_xor_b32 v128, v30, v170
    v_or3_b32 v126, v126, v127, v128
    v_xor_b32 v127, v31, v170
    v_or_b32 v126, v126, v127
    v_and_b32 v126, 15, v126
    v_cmp_ne_u32 vcc, 0, v126
    s_add_u32 s58, s58, 1
    s_cbranch_vccz L_pdoney_25
    s_cmp_lt_u32 s58, 200000
    s_cbranch_scc0 L_pdoney_25
    s_branch L_polly_24
L_pdoney_25:
    v_add_f32 v16, v16, v20
    v_add_f32 v17, v17, v21
    v_add_f32 v18, v18, v22
    v_add_f32 v19, v19, v23
    v_add_f32 v16, v16, v24
    v_add_f32 v17, v17, v25
    v_add_f32 v18, v18, v26
    v_add_f32 v19, v19, v27
    v_add_f32 v16, v16, v28
    v_add_f32 v17, v17, v29
    v_add_f32 v18, v18, v30
    v_add_f32 v19, v19, v31
    s_nop 1
    v_add_f32_dpp v16, v16, v16 row_ror:8 row_mask:0xf bank_mask:0xf
    v_add_f32_dpp v17, v17, v17 row_ror:8 row_mask:0xf bank_mask:0xf
    v_add_f32_dpp v18, v18, v18 row_ror:8 row_mask:0xf bank_mask:0xf
    v_add_f32_dpp v19, v19, v19 row_ror:8 row_mask:0xf bank_mask:0xf
    v_mov_b32 v20, v16
    v_mov_b32 v21, v17
    v_mov_b32 v22, v18
    v_mov_b32 v23, v19
    s_nop 1
    v_permlane16_swap_b32 v16, v20
    v_permlane16_swap_b32 v17, v21
    v_permlane16_swap_b32 v18, v22
    v_permlane16_swap_b32 v19, v23
    s_nop 1
    v_add_f32 v16, v16, v20
    v_add_f32 v17, v17, v21
    v_add_f32 v18, v18, v22
    v_add_f32 v19, v19, v23
    v_mov_b32 v20, v16
    v_mov_b32 v21, v17
    v_mov_b32 v22, v18
    v_mov_b32 v23, v19
    s_nop 1
    v_permlane32_swap_b32 v16, v20
    v_permlane32_swap_b32 v17, v21
    v_permlane32_swap_b32 v18, v22
    v_permlane32_swap_b32 v19, v23
    s_nop 1
    v_add_f32 v16, v16, v20
    v_add_f32 v17, v17, v21
    v_add_f32 v18, v18, v22
    v_add_f32 v19, v19, v23
    v_cvt_pk_bf16_f32 v16, v16, v16
    v_and_b32 v16, 0xffff0000, v16
    v_cvt_pk_bf16_f32 v17, v17, v17
    v_and_b32 v17, 0xffff0000, v17
    v_cvt_pk_bf16_f32 v18, v18, v18
    v_and_b32 v18, 0xffff0000, v18
    v_cvt_pk_bf16_f32 v19, v19, v19
    v_and_b32 v19, 0xffff0000, v19
    v_add_f32 v16, v16, v80
    v_add_f32 v17, v17, v81
    v_add_f32 v18, v18, v82
    v_add_f32 v19, v19, v83
    v_cvt_pk_bf16_f32 v16, v16, v16
    v_and_b32 v16, 0xffff0000, v16
    v_cvt_pk_bf16_f32 v17, v17, v17
    v_and_b32 v17, 0xffff0000, v17
    v_cvt_pk_bf16_f32 v18, v18, v18
    v_and_b32 v18, 0xffff0000, v18
    v_cvt_pk_bf16_f32 v19, v19, v19
    v_and_b32 v19, 0xffff0000, v19
    v_add_f32 v16, v16, v84
    v_add_f32 v17, v17, v85
    v_add_f32 v18, v18, v86
    v_add_f32 v19, v19, v87
    v_cvt_pk_bf16_f32 v16, v16, v16
    v_cvt_pk_bf16_f32 v17, v17, v17
    v_cvt_pk_bf16_f32 v18, v18, v18
    v_cvt_pk_bf16_f32 v19, v19, v19
    s_mov_b32 s48, s24
    s_mov_b32 s49, s25
    s_mov_b32 s50, 5120
    s_mov_b32 s51, 0x20000
    s_mov_b64 exec, 0xff
    buffer_store_short v16, v91, s[48:51], 0 offen offset:0
    buffer_store_short v17, v91, s[48:51], 0 offen offset:1280
    buffer_store_short v18, v91, s[48:51], 0 offen offset:2560
    buffer_store_short v19, v91, s[48:51], 0 offen offset:3840
    s_cmp_lg_u32 s62, 0
    s_cbranch_scc1 L_ep_26
    s_mov_b64 exec, 1
    v_mov_b32 v92, 983040
    buffer_store_dword v170, v92, s[36:39], 0 offen sc1
L_ep_26:
    s_mov_b64 exec, -1
L_stonly_23:
    s_endpgm
L_end:
    s_endpgm
.section .rodata,"a"
.p2align 6
.amdhsa_kernel parallel_sum__gqa_block_cached__dense_activation_squared_relu__decode_kernel
  .amdhsa_next_free_vgpr 248
  .amdhsa_next_free_sgpr 102
  .amdhsa_accum_offset 248
  .amdhsa_group_segment_fixed_size 0
  .amdhsa_kernarg_size 104
  .amdhsa_user_sgpr_count 2
  .amdhsa_user_sgpr_kernarg_segment_ptr 1
  .amdhsa_system_sgpr_workgroup_id_x 1
.end_amdhsa_kernel
```
